```python
import torch

def _softmax(x, axis=-1):
    return torch.softmax(x, dim=axis)
def _gelu(x):
    return torch.nn.functional.gelu(x, approximate="tanh")
def _silu(x):
    return torch.nn.functional.silu(x)
def _sigmoid(x):
    return torch.sigmoid(x)
def _layernorm(x, axis=-1, eps=1e-5):
    m = x.mean(dim=axis, keepdim=True)
    v = x.var(dim=axis, keepdim=True, unbiased=False)
    return (x - m) / torch.sqrt(v + eps)
def _scatter_add(tgt, idx, src, axis=0):
    return tgt.clone().index_add_(axis, idx, src)
def _segment_sum(src, seg, n):
    out = torch.zeros((n,) + src.shape[1:], dtype=src.dtype)
    return out.index_add_(0, seg, src)
def _pad(x, pw):
    flat = tuple(v for pair in reversed(pw) for v in pair)
    return torch.nn.functional.pad(x, flat)

kernel_name = 'sequential_preLN__gqa_block_cached__geglu_ffn__decode'

def setup_inputs():

    _w = (lambda a: (lambda t: t.to(torch.bfloat16) if t.is_floating_point() else t)(torch.as_tensor(a)))
    def _A_setup():
        B, Sq, D = 2, 1, 640
        Hq, Hkv, Sk, Dh = 32, 32, 8192, 128
        assert Hq % Hkv == 0, (Hq, Hkv)
        return {
            "x": _w((lambda *s: torch.randn(*s, dtype=torch.bfloat16) * 0.05)(B, Sq, D)),
            "k_cache": _w((lambda *s: torch.randn(*s, dtype=torch.bfloat16) * 3.2)(B, Hkv, Sk, Dh)),
            "v_cache": _w((lambda *s: torch.randn(*s, dtype=torch.bfloat16) * 0.4)(B, Hkv, Sk, Dh)),
            "wq": _w((lambda *s: torch.randn(*s, dtype=torch.bfloat16) * 3.2)(D, Hq * Dh) * (D ** -0.5)),
            "wo": _w((lambda *s: torch.randn(*s, dtype=torch.bfloat16) * 0.4)(Hq * Dh, D) * ((Hq * Dh) ** -0.5)),
        }
    _A_in = _A_setup()

    def _B_setup():
        B, S, D, F = 2, 1, 640, 1728
        return {
            "x": _w((lambda *s: torch.randn(*s, dtype=torch.bfloat16) * 0.05)(B, S, D)),
            "w_gate": _w((lambda *s: torch.randn(*s, dtype=torch.bfloat16) * 0.05)(D, F)),
            "w_up": _w((lambda *s: torch.randn(*s, dtype=torch.bfloat16) * 0.05)(D, F)),
            "w_down": _w((lambda *s: torch.randn(*s, dtype=torch.bfloat16) * 0.05)(F, D)),
        }
    _B_in = _B_setup()

    return {
        "A_x": _A_in["x"],
        "A_k_cache": _A_in["k_cache"],
        "A_v_cache": _A_in["v_cache"],
        "A_wq": _A_in["wq"],
        "A_wo": _A_in["wo"],
        "B_x": _B_in["x"],
        "B_w_gate": _B_in["w_gate"],
        "B_w_up": _B_in["w_up"],
        "B_w_down": _B_in["w_down"],
    }

def reference(A_x, A_k_cache, A_v_cache, A_wq, A_wo, B_x, B_w_gate, B_w_up, B_w_down):
    def _A_ref(x, k_cache, v_cache, wq, wo):
        B, Sq, D = x.shape
        Hq, Dh = 32, 128
        Hkv = k_cache.shape[1]
        rep = Hq // Hkv
        q = (lambda x, *d: x.permute(*d))((x @ wq).reshape(B, Sq, Hq, Dh), 0, 2, 1, 3)
        k = (lambda x, n, axis: torch.repeat_interleave(x, n, dim=axis))(k_cache, rep, axis=1)
        v = (lambda x, n, axis: torch.repeat_interleave(x, n, dim=axis))(v_cache, rep, axis=1)
        scores = torch.einsum("bhqd,bhkd->bhqk", q, k) * (Dh ** -0.5)
        p = _softmax(scores, axis=-1)
        o = torch.einsum("bhqk,bhkd->bhqd", p, v)
        return (lambda x, *d: x.permute(*d))(o, 0, 2, 1, 3).reshape(B, Sq, Hq * Dh) @ wo

    def _B_ref(x, w_gate, w_up, w_down):
        return (_gelu(x @ w_gate) * (x @ w_up)) @ w_down

    x = A_x
    h = x + _A_ref(_layernorm(x, axis=-1), A_k_cache, A_v_cache, A_wq, A_wo)
    h2 = h + _B_ref(_layernorm(h, axis=-1), B_w_gate, B_w_up, B_w_down)
    return h2
```

```asm
; @launch grid=(256,1,1) block=(512,1,1) lds=111616
.amdgcn_target "amdgcn-amd-amdhsa--gfx950"
.text
.globl sequential_preLN__gqa_block_cached__geglu_ffn__decode_kernel
.p2align 8
.type sequential_preLN__gqa_block_cached__geglu_ffn__decode_kernel,@function
sequential_preLN__gqa_block_cached__geglu_ffn__decode_kernel:
  s_cmp_ge_u32 s2, 256
  s_cbranch_scc1 L_end
  s_load_dwordx16 s[40:55], s[0:1], 0
  s_load_dwordx8 s[56:63], s[0:1], 64
  v_and_b32 v1, 63, v0
  v_lshrrev_b32 v2, 6, v0
  s_nop 0
  v_readfirstlane_b32 s3, v2
  s_and_b32 s64, s2, 7
  s_lshr_b32 s65, s2, 3
  s_and_b32 s66, s65, 3
  s_lshl_b32 s66, s66, 3
  s_add_u32 s66, s66, s64
  s_bfe_u32 s67, s65, 0x10002
  s_lshr_b32 s68, s65, 3
  v_lshlrev_b32 v3, 4, v1
  v_lshrrev_b32 v4, 4, v1
  v_and_b32 v5, 15, v1
  s_lshl_b32 s39, s67, 5
  s_add_u32 s39, s39, s66
  s_cmp_ge_u32 s3, 4
  s_cbranch_scc1 L_helper
  s_setprio 3
  s_lshl_b32 s38, s39, 21
  s_lshl_b32 s69, s68, 14
  s_add_u32 s69, s69, s38
  s_lshl_b32 s70, s3, 12
  s_add_u32 s69, s69, s70
  s_waitcnt lgkmcnt(0)
  s_mov_b32 s4, s42
  s_mov_b32 s5, s43
  s_mov_b32 s6, 0x08000000
  s_mov_b32 s7, 0x20000
  s_add_u32 s70, s69, 0
  buffer_load_dwordx4 v[48:51], v3, s[4:7], s70 offen offset:0 nt
  buffer_load_dwordx4 v[52:55], v3, s[4:7], s70 offen offset:1024 nt
  buffer_load_dwordx4 v[56:59], v3, s[4:7], s70 offen offset:2048 nt
  buffer_load_dwordx4 v[60:63], v3, s[4:7], s70 offen offset:3072 nt
  s_add_u32 s70, s69, 1048576
  buffer_load_dwordx4 v[64:67], v3, s[4:7], s70 offen offset:0 nt
  buffer_load_dwordx4 v[68:71], v3, s[4:7], s70 offen offset:1024 nt
  s_waitcnt vmcnt(5)
  buffer_load_dwordx4 v[72:75], v3, s[4:7], s70 offen offset:2048 nt
  s_waitcnt vmcnt(5)
  buffer_load_dwordx4 v[76:79], v3, s[4:7], s70 offen offset:3072 nt
  s_waitcnt vmcnt(5)
  s_add_u32 s70, s69, 65536
  buffer_load_dwordx4 v[80:83], v3, s[4:7], s70 offen offset:0 nt
  s_waitcnt vmcnt(5)
  buffer_load_dwordx4 v[84:87], v3, s[4:7], s70 offen offset:1024 nt
  s_waitcnt vmcnt(5)
  buffer_load_dwordx4 v[88:91], v3, s[4:7], s70 offen offset:2048 nt
  s_waitcnt vmcnt(5)
  buffer_load_dwordx4 v[92:95], v3, s[4:7], s70 offen offset:3072 nt
  s_waitcnt vmcnt(5)
  s_add_u32 s70, s69, 1114112
  buffer_load_dwordx4 v[96:99], v3, s[4:7], s70 offen offset:0 nt
  s_waitcnt vmcnt(5)
  buffer_load_dwordx4 v[100:103], v3, s[4:7], s70 offen offset:1024 nt
  s_waitcnt vmcnt(5)
  buffer_load_dwordx4 v[104:107], v3, s[4:7], s70 offen offset:2048 nt
  s_waitcnt vmcnt(5)
  buffer_load_dwordx4 v[108:111], v3, s[4:7], s70 offen offset:3072 nt
  s_waitcnt vmcnt(5)
  s_add_u32 s70, s69, 131072
  buffer_load_dwordx4 v[112:115], v3, s[4:7], s70 offen offset:0 nt
  s_waitcnt vmcnt(5)
  buffer_load_dwordx4 v[116:119], v3, s[4:7], s70 offen offset:1024 nt
  s_waitcnt vmcnt(5)
  buffer_load_dwordx4 v[120:123], v3, s[4:7], s70 offen offset:2048 nt
  s_waitcnt vmcnt(5)
  buffer_load_dwordx4 v[124:127], v3, s[4:7], s70 offen offset:3072 nt
  s_waitcnt vmcnt(5)
  s_add_u32 s70, s69, 1179648
  buffer_load_dwordx4 v[128:131], v3, s[4:7], s70 offen offset:0 nt
  s_waitcnt vmcnt(5)
  buffer_load_dwordx4 v[132:135], v3, s[4:7], s70 offen offset:1024 nt
  s_waitcnt vmcnt(5)
  buffer_load_dwordx4 v[136:139], v3, s[4:7], s70 offen offset:2048 nt
  s_waitcnt vmcnt(5)
  buffer_load_dwordx4 v[140:143], v3, s[4:7], s70 offen offset:3072 nt
  s_waitcnt vmcnt(5)
  s_add_u32 s70, s69, 196608
  buffer_load_dwordx4 v[144:147], v3, s[4:7], s70 offen offset:0 nt
  s_waitcnt vmcnt(5)
  buffer_load_dwordx4 v[148:151], v3, s[4:7], s70 offen offset:1024 nt
  s_waitcnt vmcnt(5)
  buffer_load_dwordx4 v[152:155], v3, s[4:7], s70 offen offset:2048 nt
  s_waitcnt vmcnt(5)
  buffer_load_dwordx4 v[156:159], v3, s[4:7], s70 offen offset:3072 nt
  s_waitcnt vmcnt(5)
  s_add_u32 s70, s69, 1245184
  buffer_load_dwordx4 v[160:163], v3, s[4:7], s70 offen offset:0 nt
  s_waitcnt vmcnt(5)
  buffer_load_dwordx4 v[164:167], v3, s[4:7], s70 offen offset:1024 nt
  s_waitcnt vmcnt(5)
  buffer_load_dwordx4 v[168:171], v3, s[4:7], s70 offen offset:2048 nt
  s_waitcnt vmcnt(5)
  buffer_load_dwordx4 v[172:175], v3, s[4:7], s70 offen offset:3072 nt
  s_waitcnt vmcnt(5)
  s_add_u32 s70, s69, 262144
  buffer_load_dwordx4 v[176:179], v3, s[4:7], s70 offen offset:0 nt
  s_waitcnt vmcnt(5)
  buffer_load_dwordx4 v[180:183], v3, s[4:7], s70 offen offset:1024 nt
  s_waitcnt vmcnt(5)
  buffer_load_dwordx4 v[184:187], v3, s[4:7], s70 offen offset:2048 nt
  s_waitcnt vmcnt(5)
  buffer_load_dwordx4 v[188:191], v3, s[4:7], s70 offen offset:3072 nt
  s_waitcnt vmcnt(5)
  s_add_u32 s70, s69, 1310720
  buffer_load_dwordx4 v[192:195], v3, s[4:7], s70 offen offset:0 nt
  s_waitcnt vmcnt(5)
  buffer_load_dwordx4 v[196:199], v3, s[4:7], s70 offen offset:1024 nt
  s_waitcnt vmcnt(5)
  buffer_load_dwordx4 v[200:203], v3, s[4:7], s70 offen offset:2048 nt
  s_waitcnt vmcnt(5)
  buffer_load_dwordx4 v[204:207], v3, s[4:7], s70 offen offset:3072 nt
  s_waitcnt vmcnt(5)
  s_add_u32 s70, s69, 327680
  buffer_load_dwordx4 v[208:211], v3, s[4:7], s70 offen offset:0 nt
  s_waitcnt vmcnt(5)
  buffer_load_dwordx4 v[212:215], v3, s[4:7], s70 offen offset:1024 nt
  s_waitcnt vmcnt(5)
  buffer_load_dwordx4 v[216:219], v3, s[4:7], s70 offen offset:2048 nt
  s_waitcnt vmcnt(5)
  buffer_load_dwordx4 v[220:223], v3, s[4:7], s70 offen offset:3072 nt
  s_mov_b32 s12, s62
  s_mov_b32 s13, s63
  s_mov_b32 s14, 524288
  s_mov_b32 s15, 0x20000
  s_mov_b32 s72, 0xcccccccc
  s_mov_b32 s73, 0xcccccccc
  s_mov_b32 s76, 1035273459
  s_mov_b32 s77, 1069066811
  v_lshlrev_b32 v36, 4, v5
  v_add_u32 v36, 65536, v36
  v_mov_b32 v38, 75904
  v_mov_b32 v39, 1
  v_lshl_add_u32 v35, v5, 2, v4
  v_lshlrev_b32 v35, 3, v35
  s_lshl_b32 s79, s3, 9
  s_add_u32 s79, s79, 67584
  v_add_u32 v35, s79, v35
  v_lshlrev_b32 v37, 3, v1
  v_add_u32 v37, 67584, v37
  v_lshlrev_b32 v42, 2, v1
  s_lshl_b32 s28, s66, 1
  s_add_u32 s28, s28, s67
  s_lshl_b32 s28, s28, 2
  s_add_u32 s28, s28, s68
  s_mul_i32 s28, s28, 256
  v_and_b32 v45, 62, v1
  v_add_u32 v45, 107520, v45
  s_lshl_b32 s79, s3, 6
  v_add_u32 v44, s79, v45
  s_add_u32 s24, s79, 1536
  s_mov_b32 s33, 64
  s_add_u32 s36, s3, 24
  s_mov_b32 s35, 0
  s_mov_b32 s37, -1
  v_mov_b32 v29, 0xff7fffff
  v_mov_b32 v10, 0
  v_mov_b32 v11, 0
  v_mov_b32 v12, 0
  v_mov_b32 v13, 0
  v_mov_b32 v14, 0
  v_mov_b32 v15, 0
  v_mov_b32 v16, 0
  v_mov_b32 v17, 0
  s_barrier
  ds_read_b128 v[6:9], v36
  s_waitcnt lgkmcnt(0)
  v_dot2_f32_bf16 v18, v48, v6, 0
  v_dot2_f32_bf16 v18, v49, v7, v18
  v_dot2_f32_bf16 v18, v50, v8, v18
  v_dot2_f32_bf16 v18, v51, v9, v18
  v_dot2_f32_bf16 v19, v52, v6, 0
  v_dot2_f32_bf16 v19, v53, v7, v19
  v_dot2_f32_bf16 v19, v54, v8, v19
  v_dot2_f32_bf16 v19, v55, v9, v19
  v_add_f32_dpp v20, v18, v18 row_ror:8 row_mask:0xf bank_mask:0x3
  s_nop 1
  v_add_f32_dpp v20, v19, v19 row_ror:8 row_mask:0xf bank_mask:0xc
  v_dot2_f32_bf16 v18, v56, v6, 0
  v_dot2_f32_bf16 v18, v57, v7, v18
  v_dot2_f32_bf16 v18, v58, v8, v18
  v_dot2_f32_bf16 v18, v59, v9, v18
  v_dot2_f32_bf16 v19, v60, v6, 0
  v_dot2_f32_bf16 v19, v61, v7, v19
  v_dot2_f32_bf16 v19, v62, v8, v19
  v_dot2_f32_bf16 v19, v63, v9, v19
  v_add_f32_dpp v21, v18, v18 row_ror:8 row_mask:0xf bank_mask:0x3
  s_nop 1
  v_add_f32_dpp v21, v19, v19 row_ror:8 row_mask:0xf bank_mask:0xc
  v_add_f32_dpp v22, v20, v20 row_shl:4 row_mask:0xf bank_mask:0x5
  s_nop 1
  v_add_f32_dpp v22, v21, v21 row_shr:4 row_mask:0xf bank_mask:0xa
  v_dot2_f32_bf16 v18, v64, v6, 0
  v_dot2_f32_bf16 v18, v65, v7, v18
  v_dot2_f32_bf16 v18, v66, v8, v18
  v_dot2_f32_bf16 v18, v67, v9, v18
  v_dot2_f32_bf16 v19, v68, v6, 0
  v_dot2_f32_bf16 v19, v69, v7, v19
  v_dot2_f32_bf16 v19, v70, v8, v19
  v_dot2_f32_bf16 v19, v71, v9, v19
  v_add_f32_dpp v20, v18, v18 row_ror:8 row_mask:0xf bank_mask:0x3
  s_nop 1
  v_add_f32_dpp v20, v19, v19 row_ror:8 row_mask:0xf bank_mask:0xc
  v_dot2_f32_bf16 v18, v72, v6, 0
  v_dot2_f32_bf16 v18, v73, v7, v18
  v_dot2_f32_bf16 v18, v74, v8, v18
  v_dot2_f32_bf16 v18, v75, v9, v18
  v_dot2_f32_bf16 v19, v76, v6, 0
  v_dot2_f32_bf16 v19, v77, v7, v19
  v_dot2_f32_bf16 v19, v78, v8, v19
  v_dot2_f32_bf16 v19, v79, v9, v19
  v_add_f32_dpp v21, v18, v18 row_ror:8 row_mask:0xf bank_mask:0x3
  s_nop 1
  v_add_f32_dpp v21, v19, v19 row_ror:8 row_mask:0xf bank_mask:0xc
  v_add_f32_dpp v23, v20, v20 row_shl:4 row_mask:0xf bank_mask:0x5
  s_nop 1
  v_add_f32_dpp v23, v21, v21 row_shr:4 row_mask:0xf bank_mask:0xa
  v_add_f32_dpp v26, v22, v22 quad_perm:[2,3,0,1] row_mask:0xf bank_mask:0xf
  s_nop 0
  v_add_f32_dpp v27, v23, v23 quad_perm:[2,3,0,1] row_mask:0xf bank_mask:0xf
  v_cndmask_b32 v28, v26, v27, s[72:73]
  s_nop 1
  v_add_f32_dpp v28, v28, v28 quad_perm:[1,0,3,2] row_mask:0xf bank_mask:0xf
  v_cvt_pk_bf16_f32 v28, v28, v28
  v_and_b32 v28, 0xffff0000, v28
  v_mul_f32 v28, s76, v28
  v_cvt_pk_bf16_f32 v28, v28, v28
  ds_write_b16 v44, v28 offset:0
  s_waitcnt vmcnt(5)
  s_add_u32 s70, s69, 1376256
  buffer_load_dwordx4 v[224:227], v3, s[4:7], s70 offen offset:0 nt
  v_dot2_f32_bf16 v18, v80, v6, 0
  v_dot2_f32_bf16 v18, v81, v7, v18
  v_dot2_f32_bf16 v18, v82, v8, v18
  v_dot2_f32_bf16 v18, v83, v9, v18
  v_dot2_f32_bf16 v19, v84, v6, 0
  v_dot2_f32_bf16 v19, v85, v7, v19
  v_dot2_f32_bf16 v19, v86, v8, v19
  v_dot2_f32_bf16 v19, v87, v9, v19
  v_add_f32_dpp v20, v18, v18 row_ror:8 row_mask:0xf bank_mask:0x3
  s_nop 1
  v_add_f32_dpp v20, v19, v19 row_ror:8 row_mask:0xf bank_mask:0xc
  v_dot2_f32_bf16 v18, v88, v6, 0
  v_dot2_f32_bf16 v18, v89, v7, v18
  v_dot2_f32_bf16 v18, v90, v8, v18
  v_dot2_f32_bf16 v18, v91, v9, v18
  v_dot2_f32_bf16 v19, v92, v6, 0
  v_dot2_f32_bf16 v19, v93, v7, v19
  v_dot2_f32_bf16 v19, v94, v8, v19
  v_dot2_f32_bf16 v19, v95, v9, v19
  v_add_f32_dpp v21, v18, v18 row_ror:8 row_mask:0xf bank_mask:0x3
  s_nop 1
  v_add_f32_dpp v21, v19, v19 row_ror:8 row_mask:0xf bank_mask:0xc
  v_add_f32_dpp v22, v20, v20 row_shl:4 row_mask:0xf bank_mask:0x5
  s_nop 1
  v_add_f32_dpp v22, v21, v21 row_shr:4 row_mask:0xf bank_mask:0xa
  v_dot2_f32_bf16 v18, v96, v6, 0
  v_dot2_f32_bf16 v18, v97, v7, v18
  v_dot2_f32_bf16 v18, v98, v8, v18
  v_dot2_f32_bf16 v18, v99, v9, v18
  v_dot2_f32_bf16 v19, v100, v6, 0
  v_dot2_f32_bf16 v19, v101, v7, v19
  v_dot2_f32_bf16 v19, v102, v8, v19
  v_dot2_f32_bf16 v19, v103, v9, v19
  v_add_f32_dpp v20, v18, v18 row_ror:8 row_mask:0xf bank_mask:0x3
  s_nop 1
  v_add_f32_dpp v20, v19, v19 row_ror:8 row_mask:0xf bank_mask:0xc
  v_dot2_f32_bf16 v18, v104, v6, 0
  v_dot2_f32_bf16 v18, v105, v7, v18
  v_dot2_f32_bf16 v18, v106, v8, v18
  v_dot2_f32_bf16 v18, v107, v9, v18
  v_dot2_f32_bf16 v19, v108, v6, 0
  v_dot2_f32_bf16 v19, v109, v7, v19
  v_dot2_f32_bf16 v19, v110, v8, v19
  v_dot2_f32_bf16 v19, v111, v9, v19
  v_add_f32_dpp v21, v18, v18 row_ror:8 row_mask:0xf bank_mask:0x3
  s_nop 1
  v_add_f32_dpp v21, v19, v19 row_ror:8 row_mask:0xf bank_mask:0xc
  v_add_f32_dpp v23, v20, v20 row_shl:4 row_mask:0xf bank_mask:0x5
  s_nop 1
  v_add_f32_dpp v23, v21, v21 row_shr:4 row_mask:0xf bank_mask:0xa
  v_add_f32_dpp v26, v22, v22 quad_perm:[2,3,0,1] row_mask:0xf bank_mask:0xf
  s_nop 0
  v_add_f32_dpp v27, v23, v23 quad_perm:[2,3,0,1] row_mask:0xf bank_mask:0xf
  v_cndmask_b32 v28, v26, v27, s[72:73]
  s_nop 1
  v_add_f32_dpp v28, v28, v28 quad_perm:[1,0,3,2] row_mask:0xf bank_mask:0xf
  v_cvt_pk_bf16_f32 v28, v28, v28
  v_and_b32 v28, 0xffff0000, v28
  v_mul_f32 v28, s76, v28
  v_cvt_pk_bf16_f32 v28, v28, v28
  ds_write_b16 v44, v28 offset:256
  s_waitcnt vmcnt(5)
  buffer_load_dwordx4 v[228:231], v3, s[4:7], s70 offen offset:1024 nt
  v_dot2_f32_bf16 v18, v112, v6, 0
  v_dot2_f32_bf16 v18, v113, v7, v18
  v_dot2_f32_bf16 v18, v114, v8, v18
  v_dot2_f32_bf16 v18, v115, v9, v18
  v_dot2_f32_bf16 v19, v116, v6, 0
  v_dot2_f32_bf16 v19, v117, v7, v19
  v_dot2_f32_bf16 v19, v118, v8, v19
  v_dot2_f32_bf16 v19, v119, v9, v19
  v_add_f32_dpp v20, v18, v18 row_ror:8 row_mask:0xf bank_mask:0x3
  s_nop 1
  v_add_f32_dpp v20, v19, v19 row_ror:8 row_mask:0xf bank_mask:0xc
  v_dot2_f32_bf16 v18, v120, v6, 0
  v_dot2_f32_bf16 v18, v121, v7, v18
  v_dot2_f32_bf16 v18, v122, v8, v18
  v_dot2_f32_bf16 v18, v123, v9, v18
  v_dot2_f32_bf16 v19, v124, v6, 0
  v_dot2_f32_bf16 v19, v125, v7, v19
  v_dot2_f32_bf16 v19, v126, v8, v19
  v_dot2_f32_bf16 v19, v127, v9, v19
  v_add_f32_dpp v21, v18, v18 row_ror:8 row_mask:0xf bank_mask:0x3
  s_nop 1
  v_add_f32_dpp v21, v19, v19 row_ror:8 row_mask:0xf bank_mask:0xc
  v_add_f32_dpp v22, v20, v20 row_shl:4 row_mask:0xf bank_mask:0x5
  s_nop 1
  v_add_f32_dpp v22, v21, v21 row_shr:4 row_mask:0xf bank_mask:0xa
  v_dot2_f32_bf16 v18, v128, v6, 0
  v_dot2_f32_bf16 v18, v129, v7, v18
  v_dot2_f32_bf16 v18, v130, v8, v18
  v_dot2_f32_bf16 v18, v131, v9, v18
  v_dot2_f32_bf16 v19, v132, v6, 0
  v_dot2_f32_bf16 v19, v133, v7, v19
  v_dot2_f32_bf16 v19, v134, v8, v19
  v_dot2_f32_bf16 v19, v135, v9, v19
  v_add_f32_dpp v20, v18, v18 row_ror:8 row_mask:0xf bank_mask:0x3
  s_nop 1
  v_add_f32_dpp v20, v19, v19 row_ror:8 row_mask:0xf bank_mask:0xc
  v_dot2_f32_bf16 v18, v136, v6, 0
  v_dot2_f32_bf16 v18, v137, v7, v18
  v_dot2_f32_bf16 v18, v138, v8, v18
  v_dot2_f32_bf16 v18, v139, v9, v18
  v_dot2_f32_bf16 v19, v140, v6, 0
  v_dot2_f32_bf16 v19, v141, v7, v19
  v_dot2_f32_bf16 v19, v142, v8, v19
  v_dot2_f32_bf16 v19, v143, v9, v19
  v_add_f32_dpp v21, v18, v18 row_ror:8 row_mask:0xf bank_mask:0x3
  s_nop 1
  v_add_f32_dpp v21, v19, v19 row_ror:8 row_mask:0xf bank_mask:0xc
  v_add_f32_dpp v23, v20, v20 row_shl:4 row_mask:0xf bank_mask:0x5
  s_nop 1
  v_add_f32_dpp v23, v21, v21 row_shr:4 row_mask:0xf bank_mask:0xa
  v_add_f32_dpp v26, v22, v22 quad_perm:[2,3,0,1] row_mask:0xf bank_mask:0xf
  s_nop 0
  v_add_f32_dpp v27, v23, v23 quad_perm:[2,3,0,1] row_mask:0xf bank_mask:0xf
  v_cndmask_b32 v28, v26, v27, s[72:73]
  s_nop 1
  v_add_f32_dpp v28, v28, v28 quad_perm:[1,0,3,2] row_mask:0xf bank_mask:0xf
  v_cvt_pk_bf16_f32 v28, v28, v28
  v_and_b32 v28, 0xffff0000, v28
  v_mul_f32 v28, s76, v28
  v_cvt_pk_bf16_f32 v28, v28, v28
  ds_write_b16 v44, v28 offset:512
  s_waitcnt vmcnt(5)
  buffer_load_dwordx4 v[232:235], v3, s[4:7], s70 offen offset:2048 nt
  v_dot2_f32_bf16 v18, v144, v6, 0
  v_dot2_f32_bf16 v18, v145, v7, v18
  v_dot2_f32_bf16 v18, v146, v8, v18
  v_dot2_f32_bf16 v18, v147, v9, v18
  v_dot2_f32_bf16 v19, v148, v6, 0
  v_dot2_f32_bf16 v19, v149, v7, v19
  v_dot2_f32_bf16 v19, v150, v8, v19
  v_dot2_f32_bf16 v19, v151, v9, v19
  v_add_f32_dpp v20, v18, v18 row_ror:8 row_mask:0xf bank_mask:0x3
  s_nop 1
  v_add_f32_dpp v20, v19, v19 row_ror:8 row_mask:0xf bank_mask:0xc
  v_dot2_f32_bf16 v18, v152, v6, 0
  v_dot2_f32_bf16 v18, v153, v7, v18
  v_dot2_f32_bf16 v18, v154, v8, v18
  v_dot2_f32_bf16 v18, v155, v9, v18
  v_dot2_f32_bf16 v19, v156, v6, 0
  v_dot2_f32_bf16 v19, v157, v7, v19
  v_dot2_f32_bf16 v19, v158, v8, v19
  v_dot2_f32_bf16 v19, v159, v9, v19
  v_add_f32_dpp v21, v18, v18 row_ror:8 row_mask:0xf bank_mask:0x3
  s_nop 1
  v_add_f32_dpp v21, v19, v19 row_ror:8 row_mask:0xf bank_mask:0xc
  v_add_f32_dpp v22, v20, v20 row_shl:4 row_mask:0xf bank_mask:0x5
  s_nop 1
  v_add_f32_dpp v22, v21, v21 row_shr:4 row_mask:0xf bank_mask:0xa
  v_dot2_f32_bf16 v18, v160, v6, 0
  v_dot2_f32_bf16 v18, v161, v7, v18
  v_dot2_f32_bf16 v18, v162, v8, v18
  v_dot2_f32_bf16 v18, v163, v9, v18
  v_dot2_f32_bf16 v19, v164, v6, 0
  v_dot2_f32_bf16 v19, v165, v7, v19
  v_dot2_f32_bf16 v19, v166, v8, v19
  v_dot2_f32_bf16 v19, v167, v9, v19
  v_add_f32_dpp v20, v18, v18 row_ror:8 row_mask:0xf bank_mask:0x3
  s_nop 1
  v_add_f32_dpp v20, v19, v19 row_ror:8 row_mask:0xf bank_mask:0xc
  v_dot2_f32_bf16 v18, v168, v6, 0
  v_dot2_f32_bf16 v18, v169, v7, v18
  v_dot2_f32_bf16 v18, v170, v8, v18
  v_dot2_f32_bf16 v18, v171, v9, v18
  v_dot2_f32_bf16 v19, v172, v6, 0
  v_dot2_f32_bf16 v19, v173, v7, v19
  v_dot2_f32_bf16 v19, v174, v8, v19
  v_dot2_f32_bf16 v19, v175, v9, v19
  v_add_f32_dpp v21, v18, v18 row_ror:8 row_mask:0xf bank_mask:0x3
  s_nop 1
  v_add_f32_dpp v21, v19, v19 row_ror:8 row_mask:0xf bank_mask:0xc
  v_add_f32_dpp v23, v20, v20 row_shl:4 row_mask:0xf bank_mask:0x5
  s_nop 1
  v_add_f32_dpp v23, v21, v21 row_shr:4 row_mask:0xf bank_mask:0xa
  v_add_f32_dpp v26, v22, v22 quad_perm:[2,3,0,1] row_mask:0xf bank_mask:0xf
  s_nop 0
  v_add_f32_dpp v27, v23, v23 quad_perm:[2,3,0,1] row_mask:0xf bank_mask:0xf
  v_cndmask_b32 v28, v26, v27, s[72:73]
  s_nop 1
  v_add_f32_dpp v28, v28, v28 quad_perm:[1,0,3,2] row_mask:0xf bank_mask:0xf
  v_cvt_pk_bf16_f32 v28, v28, v28
  v_and_b32 v28, 0xffff0000, v28
  v_mul_f32 v28, s76, v28
  v_cvt_pk_bf16_f32 v28, v28, v28
  ds_write_b16 v44, v28 offset:768
  s_waitcnt vmcnt(5)
  buffer_load_dwordx4 v[236:239], v3, s[4:7], s70 offen offset:3072 nt
  s_add_u32 s70, s69, 393216
  s_add_u32 s31, s69, 1441792
  s_waitcnt vmcnt(4)
  buffer_load_dwordx4 v[48:51], v3, s[4:7], s70 offen offset:0 nt
  s_waitcnt vmcnt(16)
  v_dot2_f32_bf16 v18, v176, v6, 0
  v_dot2_f32_bf16 v18, v177, v7, v18
  v_dot2_f32_bf16 v18, v178, v8, v18
  v_dot2_f32_bf16 v18, v179, v9, v18
  s_waitcnt vmcnt(15)
  v_dot2_f32_bf16 v19, v180, v6, 0
  v_dot2_f32_bf16 v19, v181, v7, v19
  v_dot2_f32_bf16 v19, v182, v8, v19
  v_dot2_f32_bf16 v19, v183, v9, v19
  v_add_f32_dpp v20, v18, v18 row_ror:8 row_mask:0xf bank_mask:0x3
  s_nop 1
  v_add_f32_dpp v20, v19, v19 row_ror:8 row_mask:0xf bank_mask:0xc
  s_waitcnt vmcnt(14)
  v_dot2_f32_bf16 v18, v184, v6, 0
  v_dot2_f32_bf16 v18, v185, v7, v18
  v_dot2_f32_bf16 v18, v186, v8, v18
  v_dot2_f32_bf16 v18, v187, v9, v18
  s_waitcnt vmcnt(4)
  buffer_load_dwordx4 v[52:55], v3, s[4:7], s70 offen offset:1024 nt
  s_waitcnt vmcnt(14)
  v_dot2_f32_bf16 v19, v188, v6, 0
  v_dot2_f32_bf16 v19, v189, v7, v19
  v_dot2_f32_bf16 v19, v190, v8, v19
  v_dot2_f32_bf16 v19, v191, v9, v19
  v_add_f32_dpp v21, v18, v18 row_ror:8 row_mask:0xf bank_mask:0x3
  s_nop 1
  v_add_f32_dpp v21, v19, v19 row_ror:8 row_mask:0xf bank_mask:0xc
  v_add_f32_dpp v22, v20, v20 row_shl:4 row_mask:0xf bank_mask:0x5
  s_nop 1
  v_add_f32_dpp v22, v21, v21 row_shr:4 row_mask:0xf bank_mask:0xa
  s_waitcnt vmcnt(13)
  v_dot2_f32_bf16 v18, v192, v6, 0
  v_dot2_f32_bf16 v18, v193, v7, v18
  v_dot2_f32_bf16 v18, v194, v8, v18
  v_dot2_f32_bf16 v18, v195, v9, v18
  s_waitcnt vmcnt(12)
  v_dot2_f32_bf16 v19, v196, v6, 0
  v_dot2_f32_bf16 v19, v197, v7, v19
  v_dot2_f32_bf16 v19, v198, v8, v19
  v_dot2_f32_bf16 v19, v199, v9, v19
  v_add_f32_dpp v20, v18, v18 row_ror:8 row_mask:0xf bank_mask:0x3
  s_nop 1
  v_add_f32_dpp v20, v19, v19 row_ror:8 row_mask:0xf bank_mask:0xc
  s_waitcnt vmcnt(4)
  buffer_load_dwordx4 v[56:59], v3, s[4:7], s70 offen offset:2048 nt
  s_waitcnt vmcnt(12)
  v_dot2_f32_bf16 v18, v200, v6, 0
  v_dot2_f32_bf16 v18, v201, v7, v18
  v_dot2_f32_bf16 v18, v202, v8, v18
  v_dot2_f32_bf16 v18, v203, v9, v18
  s_waitcnt vmcnt(11)
  v_dot2_f32_bf16 v19, v204, v6, 0
  v_dot2_f32_bf16 v19, v205, v7, v19
  v_dot2_f32_bf16 v19, v206, v8, v19
  v_dot2_f32_bf16 v19, v207, v9, v19
  v_add_f32_dpp v21, v18, v18 row_ror:8 row_mask:0xf bank_mask:0x3
  s_nop 1
  v_add_f32_dpp v21, v19, v19 row_ror:8 row_mask:0xf bank_mask:0xc
  v_add_f32_dpp v23, v20, v20 row_shl:4 row_mask:0xf bank_mask:0x5
  s_nop 1
  v_add_f32_dpp v23, v21, v21 row_shr:4 row_mask:0xf bank_mask:0xa
  v_add_f32_dpp v26, v22, v22 quad_perm:[2,3,0,1] row_mask:0xf bank_mask:0xf
  s_nop 0
  v_add_f32_dpp v27, v23, v23 quad_perm:[2,3,0,1] row_mask:0xf bank_mask:0xf
  v_cndmask_b32 v28, v26, v27, s[72:73]
  s_nop 1
  v_add_f32_dpp v28, v28, v28 quad_perm:[1,0,3,2] row_mask:0xf bank_mask:0xf
  v_cvt_pk_bf16_f32 v28, v28, v28
  v_and_b32 v28, 0xffff0000, v28
  v_mul_f32 v28, s76, v28
  v_cvt_pk_bf16_f32 v28, v28, v28
  ds_write_b16 v44, v28 offset:1024
  s_waitcnt vmcnt(4)
  buffer_load_dwordx4 v[60:63], v3, s[4:7], s70 offen offset:3072 nt
  s_waitcnt vmcnt(11)
  v_dot2_f32_bf16 v18, v208, v6, 0
  v_dot2_f32_bf16 v18, v209, v7, v18
  v_dot2_f32_bf16 v18, v210, v8, v18
  v_dot2_f32_bf16 v18, v211, v9, v18
  s_waitcnt vmcnt(10)
  v_dot2_f32_bf16 v19, v212, v6, 0
  v_dot2_f32_bf16 v19, v213, v7, v19
  v_dot2_f32_bf16 v19, v214, v8, v19
  v_dot2_f32_bf16 v19, v215, v9, v19
  v_add_f32_dpp v20, v18, v18 row_ror:8 row_mask:0xf bank_mask:0x3
  s_nop 1
  v_add_f32_dpp v20, v19, v19 row_ror:8 row_mask:0xf bank_mask:0xc
  s_waitcnt vmcnt(9)
  v_dot2_f32_bf16 v18, v216, v6, 0
  v_dot2_f32_bf16 v18, v217, v7, v18
  v_dot2_f32_bf16 v18, v218, v8, v18
  v_dot2_f32_bf16 v18, v219, v9, v18
  s_waitcnt vmcnt(4)
  buffer_load_dwordx4 v[64:67], v3, s[4:7], s31 offen offset:0 nt
  s_waitcnt vmcnt(9)
  v_dot2_f32_bf16 v19, v220, v6, 0
  v_dot2_f32_bf16 v19, v221, v7, v19
  v_dot2_f32_bf16 v19, v222, v8, v19
  v_dot2_f32_bf16 v19, v223, v9, v19
  v_add_f32_dpp v21, v18, v18 row_ror:8 row_mask:0xf bank_mask:0x3
  s_nop 1
  v_add_f32_dpp v21, v19, v19 row_ror:8 row_mask:0xf bank_mask:0xc
  v_add_f32_dpp v22, v20, v20 row_shl:4 row_mask:0xf bank_mask:0x5
  s_nop 1
  v_add_f32_dpp v22, v21, v21 row_shr:4 row_mask:0xf bank_mask:0xa
  s_waitcnt vmcnt(8)
  v_dot2_f32_bf16 v18, v224, v6, 0
  v_dot2_f32_bf16 v18, v225, v7, v18
  v_dot2_f32_bf16 v18, v226, v8, v18
  v_dot2_f32_bf16 v18, v227, v9, v18
  s_waitcnt vmcnt(7)
  v_dot2_f32_bf16 v19, v228, v6, 0
  v_dot2_f32_bf16 v19, v229, v7, v19
  v_dot2_f32_bf16 v19, v230, v8, v19
  v_dot2_f32_bf16 v19, v231, v9, v19
  v_add_f32_dpp v20, v18, v18 row_ror:8 row_mask:0xf bank_mask:0x3
  s_nop 1
  v_add_f32_dpp v20, v19, v19 row_ror:8 row_mask:0xf bank_mask:0xc
  s_waitcnt vmcnt(4)
  buffer_load_dwordx4 v[68:71], v3, s[4:7], s31 offen offset:1024 nt
  s_waitcnt vmcnt(7)
  v_dot2_f32_bf16 v18, v232, v6, 0
  v_dot2_f32_bf16 v18, v233, v7, v18
  v_dot2_f32_bf16 v18, v234, v8, v18
  v_dot2_f32_bf16 v18, v235, v9, v18
  s_waitcnt vmcnt(6)
  v_dot2_f32_bf16 v19, v236, v6, 0
  v_dot2_f32_bf16 v19, v237, v7, v19
  v_dot2_f32_bf16 v19, v238, v8, v19
  v_dot2_f32_bf16 v19, v239, v9, v19
  v_add_f32_dpp v21, v18, v18 row_ror:8 row_mask:0xf bank_mask:0x3
  s_nop 1
  v_add_f32_dpp v21, v19, v19 row_ror:8 row_mask:0xf bank_mask:0xc
  v_add_f32_dpp v23, v20, v20 row_shl:4 row_mask:0xf bank_mask:0x5
  s_nop 1
  v_add_f32_dpp v23, v21, v21 row_shr:4 row_mask:0xf bank_mask:0xa
  v_add_f32_dpp v26, v22, v22 quad_perm:[2,3,0,1] row_mask:0xf bank_mask:0xf
  s_nop 0
  v_add_f32_dpp v27, v23, v23 quad_perm:[2,3,0,1] row_mask:0xf bank_mask:0xf
  v_cndmask_b32 v28, v26, v27, s[72:73]
  s_nop 1
  v_add_f32_dpp v28, v28, v28 quad_perm:[1,0,3,2] row_mask:0xf bank_mask:0xf
  v_cvt_pk_bf16_f32 v28, v28, v28
  v_and_b32 v28, 0xffff0000, v28
  v_mul_f32 v28, s76, v28
  v_cvt_pk_bf16_f32 v28, v28, v28
  ds_write_b16 v44, v28 offset:1280
  s_waitcnt vmcnt(4)
  buffer_load_dwordx4 v[72:75], v3, s[4:7], s31 offen offset:2048 nt
  s_waitcnt vmcnt(4)
  buffer_load_dwordx4 v[76:79], v3, s[4:7], s31 offen offset:3072 nt
  s_mov_b64 exec, 1
  ds_add_u32 v38, v39 offset:0
  ds_read_b64 v[40:41], v38 offset:40
  s_mov_b64 exec, -1
.p2align 3
L_kloop:
  s_waitcnt lgkmcnt(0)
  s_add_u32 s36, s36, 4
  v_readfirstlane_b32 s34, v41
  v_readfirstlane_b32 s32, v40
  s_nop 0
  s_cmp_lt_u32 s36, s32
  s_cselect_b64 vcc, -1, 0
  s_nop 1
L_rK0:
  s_cmp_ge_u32 s36, s33
  s_cbranch_scc1 L_limK0
  s_and_b32 s79, s36, 63
  s_lshl_b32 s25, s79, 6
  s_lshr_b32 s70, s79, 2
  s_lshl_b32 s70, s70, 16
  s_add_u32 s70, s70, s69
  s_add_u32 s31, s70, 1048576
  s_cmp_lt_u32 s36, s34
  s_cbranch_vccnz L_thK0_0
  s_cbranch_scc0 L_tnK0_0
  s_waitcnt vmcnt(3)
L_tnK0_0:
  s_waitcnt vmcnt(4)
L_thK0_0:
  s_waitcnt vmcnt(6)
  buffer_load_dwordx4 v[80:83], v3, s[4:7], s70 offen offset:0 nt
  v_dot2_f32_bf16 v18, v48, v6, 0
  v_dot2_f32_bf16 v18, v49, v7, v18
  v_dot2_f32_bf16 v18, v50, v8, v18
  v_dot2_f32_bf16 v18, v51, v9, v18
  s_nop 1
  s_cbranch_vccnz L_thK0_1
  s_cbranch_scc0 L_tnK0_1
  s_waitcnt vmcnt(3)
L_tnK0_1:
  s_waitcnt vmcnt(4)
L_thK0_1:
  s_waitcnt vmcnt(6)
  buffer_load_dwordx4 v[84:87], v3, s[4:7], s70 offen offset:1024 nt
  v_dot2_f32_bf16 v19, v52, v6, 0
  v_dot2_f32_bf16 v19, v53, v7, v19
  v_dot2_f32_bf16 v19, v54, v8, v19
  v_dot2_f32_bf16 v19, v55, v9, v19
  v_add_f32_dpp v20, v18, v18 row_ror:8 row_mask:0xf bank_mask:0x3
  s_nop 1
  v_add_f32_dpp v20, v19, v19 row_ror:8 row_mask:0xf bank_mask:0xc
  s_nop 0
  s_cbranch_vccnz L_thK0_2
  s_cbranch_scc0 L_tnK0_2
  s_waitcnt vmcnt(3)
L_tnK0_2:
  s_waitcnt vmcnt(4)
L_thK0_2:
  s_waitcnt vmcnt(6)
  buffer_load_dwordx4 v[88:91], v3, s[4:7], s70 offen offset:2048 nt
  v_dot2_f32_bf16 v18, v56, v6, 0
  v_dot2_f32_bf16 v18, v57, v7, v18
  v_dot2_f32_bf16 v18, v58, v8, v18
  v_dot2_f32_bf16 v18, v59, v9, v18
  s_nop 1
  s_cbranch_vccnz L_thK0_3
  s_cbranch_scc0 L_tnK0_3
  s_waitcnt vmcnt(3)
L_tnK0_3:
  s_waitcnt vmcnt(4)
L_thK0_3:
  s_waitcnt vmcnt(6)
  buffer_load_dwordx4 v[92:95], v3, s[4:7], s70 offen offset:3072 nt
  v_dot2_f32_bf16 v19, v60, v6, 0
  v_dot2_f32_bf16 v19, v61, v7, v19
  v_dot2_f32_bf16 v19, v62, v8, v19
  v_dot2_f32_bf16 v19, v63, v9, v19
  v_add_f32_dpp v21, v18, v18 row_ror:8 row_mask:0xf bank_mask:0x3
  s_nop 1
  v_add_f32_dpp v21, v19, v19 row_ror:8 row_mask:0xf bank_mask:0xc
  v_add_f32_dpp v22, v20, v20 row_shl:4 row_mask:0xf bank_mask:0x5
  s_nop 1
  v_add_f32_dpp v22, v21, v21 row_shr:4 row_mask:0xf bank_mask:0xa
  s_nop 0
  s_cbranch_vccnz L_thK0_4
  s_cbranch_scc0 L_tnK0_4
  s_waitcnt vmcnt(3)
L_tnK0_4:
  s_waitcnt vmcnt(4)
L_thK0_4:
  s_waitcnt vmcnt(6)
  buffer_load_dwordx4 v[96:99], v3, s[4:7], s31 offen offset:0 nt
  v_dot2_f32_bf16 v18, v64, v6, 0
  v_dot2_f32_bf16 v18, v65, v7, v18
  v_dot2_f32_bf16 v18, v66, v8, v18
  v_dot2_f32_bf16 v18, v67, v9, v18
  s_nop 1
  s_cbranch_vccnz L_thK0_5
  s_cbranch_scc0 L_tnK0_5
  s_waitcnt vmcnt(3)
L_tnK0_5:
  s_waitcnt vmcnt(4)
L_thK0_5:
  s_waitcnt vmcnt(6)
  buffer_load_dwordx4 v[100:103], v3, s[4:7], s31 offen offset:1024 nt
  v_dot2_f32_bf16 v19, v68, v6, 0
  v_dot2_f32_bf16 v19, v69, v7, v19
  v_dot2_f32_bf16 v19, v70, v8, v19
  v_dot2_f32_bf16 v19, v71, v9, v19
  v_add_f32_dpp v20, v18, v18 row_ror:8 row_mask:0xf bank_mask:0x3
  s_nop 1
  v_add_f32_dpp v20, v19, v19 row_ror:8 row_mask:0xf bank_mask:0xc
  s_nop 0
  s_cbranch_vccnz L_thK0_6
  s_cbranch_scc0 L_tnK0_6
  s_waitcnt vmcnt(3)
L_tnK0_6:
  s_waitcnt vmcnt(4)
L_thK0_6:
  s_waitcnt vmcnt(6)
  buffer_load_dwordx4 v[104:107], v3, s[4:7], s31 offen offset:2048 nt
  v_dot2_f32_bf16 v18, v72, v6, 0
  v_dot2_f32_bf16 v18, v73, v7, v18
  v_dot2_f32_bf16 v18, v74, v8, v18
  v_dot2_f32_bf16 v18, v75, v9, v18
  s_nop 1
  s_cbranch_vccnz L_thK0_7
  s_cbranch_scc0 L_tnK0_7
  s_waitcnt vmcnt(3)
L_tnK0_7:
  s_waitcnt vmcnt(4)
L_thK0_7:
  s_waitcnt vmcnt(6)
  buffer_load_dwordx4 v[108:111], v3, s[4:7], s31 offen offset:3072 nt
  s_mov_b64 exec, 1
  ds_add_u32 v38, v39 offset:0
  ds_read_b64 v[40:41], v38 offset:40
  s_mov_b64 exec, -1
  v_dot2_f32_bf16 v19, v76, v6, 0
  v_dot2_f32_bf16 v19, v77, v7, v19
  v_dot2_f32_bf16 v19, v78, v8, v19
  v_dot2_f32_bf16 v19, v79, v9, v19
  v_add_f32_dpp v21, v18, v18 row_ror:8 row_mask:0xf bank_mask:0x3
  s_nop 1
  v_add_f32_dpp v21, v19, v19 row_ror:8 row_mask:0xf bank_mask:0xc
  v_add_f32_dpp v23, v20, v20 row_shl:4 row_mask:0xf bank_mask:0x5
  s_nop 1
  v_add_f32_dpp v23, v21, v21 row_shr:4 row_mask:0xf bank_mask:0xa
  v_add_f32_dpp v26, v22, v22 quad_perm:[2,3,0,1] row_mask:0xf bank_mask:0xf
  s_nop 0
  v_add_f32_dpp v27, v23, v23 quad_perm:[2,3,0,1] row_mask:0xf bank_mask:0xf
  v_cndmask_b32 v28, v26, v27, s[72:73]
  s_nop 1
  v_add_f32_dpp v28, v28, v28 quad_perm:[1,0,3,2] row_mask:0xf bank_mask:0xf
  v_cvt_pk_bf16_f32 v28, v28, v28
  v_and_b32 v28, 0xffff0000, v28
  v_mul_f32 v28, s76, v28
  v_cvt_pk_bf16_f32 v28, v28, v28
  v_add_u32 v43, s24, v45
  ds_write_b16 v43, v28
  s_cmp_lg_u32 s35, 0
  s_cbranch_scc1 L_vent1
  s_waitcnt lgkmcnt(0)
  s_add_u32 s36, s36, 4
  v_readfirstlane_b32 s34, v41
  v_readfirstlane_b32 s32, v40
  s_nop 0
  s_cmp_lt_u32 s36, s32
  s_cselect_b64 vcc, -1, 0
  s_nop 1
L_rK1:
  s_cmp_ge_u32 s36, s33
  s_cbranch_scc1 L_limK1
  s_and_b32 s79, s36, 63
  s_lshl_b32 s24, s79, 6
  s_lshr_b32 s70, s79, 2
  s_lshl_b32 s70, s70, 16
  s_add_u32 s70, s70, s69
  s_add_u32 s31, s70, 1048576
  s_cmp_lt_u32 s36, s34
  s_cbranch_vccnz L_thK1_0
  s_cbranch_scc0 L_tnK1_0
  s_waitcnt vmcnt(3)
L_tnK1_0:
  s_waitcnt vmcnt(4)
L_thK1_0:
  s_waitcnt vmcnt(6)
  buffer_load_dwordx4 v[48:51], v3, s[4:7], s70 offen offset:0 nt
  v_dot2_f32_bf16 v18, v80, v6, 0
  v_dot2_f32_bf16 v18, v81, v7, v18
  v_dot2_f32_bf16 v18, v82, v8, v18
  v_dot2_f32_bf16 v18, v83, v9, v18
  s_nop 1
  s_cbranch_vccnz L_thK1_1
  s_cbranch_scc0 L_tnK1_1
  s_waitcnt vmcnt(3)
L_tnK1_1:
  s_waitcnt vmcnt(4)
L_thK1_1:
  s_waitcnt vmcnt(6)
  buffer_load_dwordx4 v[52:55], v3, s[4:7], s70 offen offset:1024 nt
  v_dot2_f32_bf16 v19, v84, v6, 0
  v_dot2_f32_bf16 v19, v85, v7, v19
  v_dot2_f32_bf16 v19, v86, v8, v19
  v_dot2_f32_bf16 v19, v87, v9, v19
  v_add_f32_dpp v20, v18, v18 row_ror:8 row_mask:0xf bank_mask:0x3
  s_nop 1
  v_add_f32_dpp v20, v19, v19 row_ror:8 row_mask:0xf bank_mask:0xc
  s_nop 0
  s_cbranch_vccnz L_thK1_2
  s_cbranch_scc0 L_tnK1_2
  s_waitcnt vmcnt(3)
L_tnK1_2:
  s_waitcnt vmcnt(4)
L_thK1_2:
  s_waitcnt vmcnt(6)
  buffer_load_dwordx4 v[56:59], v3, s[4:7], s70 offen offset:2048 nt
  v_dot2_f32_bf16 v18, v88, v6, 0
  v_dot2_f32_bf16 v18, v89, v7, v18
  v_dot2_f32_bf16 v18, v90, v8, v18
  v_dot2_f32_bf16 v18, v91, v9, v18
  s_nop 1
  s_cbranch_vccnz L_thK1_3
  s_cbranch_scc0 L_tnK1_3
  s_waitcnt vmcnt(3)
L_tnK1_3:
  s_waitcnt vmcnt(4)
L_thK1_3:
  s_waitcnt vmcnt(6)
  buffer_load_dwordx4 v[60:63], v3, s[4:7], s70 offen offset:3072 nt
  v_dot2_f32_bf16 v19, v92, v6, 0
  v_dot2_f32_bf16 v19, v93, v7, v19
  v_dot2_f32_bf16 v19, v94, v8, v19
  v_dot2_f32_bf16 v19, v95, v9, v19
  v_add_f32_dpp v21, v18, v18 row_ror:8 row_mask:0xf bank_mask:0x3
  s_nop 1
  v_add_f32_dpp v21, v19, v19 row_ror:8 row_mask:0xf bank_mask:0xc
  v_add_f32_dpp v22, v20, v20 row_shl:4 row_mask:0xf bank_mask:0x5
  s_nop 1
  v_add_f32_dpp v22, v21, v21 row_shr:4 row_mask:0xf bank_mask:0xa
  s_nop 0
  s_cbranch_vccnz L_thK1_4
  s_cbranch_scc0 L_tnK1_4
  s_waitcnt vmcnt(3)
L_tnK1_4:
  s_waitcnt vmcnt(4)
L_thK1_4:
  s_waitcnt vmcnt(6)
  buffer_load_dwordx4 v[64:67], v3, s[4:7], s31 offen offset:0 nt
  v_dot2_f32_bf16 v18, v96, v6, 0
  v_dot2_f32_bf16 v18, v97, v7, v18
  v_dot2_f32_bf16 v18, v98, v8, v18
  v_dot2_f32_bf16 v18, v99, v9, v18
  s_nop 1
  s_cbranch_vccnz L_thK1_5
  s_cbranch_scc0 L_tnK1_5
  s_waitcnt vmcnt(3)
L_tnK1_5:
  s_waitcnt vmcnt(4)
L_thK1_5:
  s_waitcnt vmcnt(6)
  buffer_load_dwordx4 v[68:71], v3, s[4:7], s31 offen offset:1024 nt
  v_dot2_f32_bf16 v19, v100, v6, 0
  v_dot2_f32_bf16 v19, v101, v7, v19
  v_dot2_f32_bf16 v19, v102, v8, v19
  v_dot2_f32_bf16 v19, v103, v9, v19
  v_add_f32_dpp v20, v18, v18 row_ror:8 row_mask:0xf bank_mask:0x3
  s_nop 1
  v_add_f32_dpp v20, v19, v19 row_ror:8 row_mask:0xf bank_mask:0xc
  s_nop 0
  s_cbranch_vccnz L_thK1_6
  s_cbranch_scc0 L_tnK1_6
  s_waitcnt vmcnt(3)
L_tnK1_6:
  s_waitcnt vmcnt(4)
L_thK1_6:
  s_waitcnt vmcnt(6)
  buffer_load_dwordx4 v[72:75], v3, s[4:7], s31 offen offset:2048 nt
  v_dot2_f32_bf16 v18, v104, v6, 0
  v_dot2_f32_bf16 v18, v105, v7, v18
  v_dot2_f32_bf16 v18, v106, v8, v18
  v_dot2_f32_bf16 v18, v107, v9, v18
  s_nop 1
  s_cbranch_vccnz L_thK1_7
  s_cbranch_scc0 L_tnK1_7
  s_waitcnt vmcnt(3)
L_tnK1_7:
  s_waitcnt vmcnt(4)
L_thK1_7:
  s_waitcnt vmcnt(6)
  buffer_load_dwordx4 v[76:79], v3, s[4:7], s31 offen offset:3072 nt
  s_mov_b64 exec, 1
  ds_add_u32 v38, v39 offset:0
  ds_read_b64 v[40:41], v38 offset:40
  s_mov_b64 exec, -1
  v_dot2_f32_bf16 v19, v108, v6, 0
  v_dot2_f32_bf16 v19, v109, v7, v19
  v_dot2_f32_bf16 v19, v110, v8, v19
  v_dot2_f32_bf16 v19, v111, v9, v19
  v_add_f32_dpp v21, v18, v18 row_ror:8 row_mask:0xf bank_mask:0x3
  s_nop 1
  v_add_f32_dpp v21, v19, v19 row_ror:8 row_mask:0xf bank_mask:0xc
  v_add_f32_dpp v23, v20, v20 row_shl:4 row_mask:0xf bank_mask:0x5
  s_nop 1
  v_add_f32_dpp v23, v21, v21 row_shr:4 row_mask:0xf bank_mask:0xa
  v_add_f32_dpp v26, v22, v22 quad_perm:[2,3,0,1] row_mask:0xf bank_mask:0xf
  s_nop 0
  v_add_f32_dpp v27, v23, v23 quad_perm:[2,3,0,1] row_mask:0xf bank_mask:0xf
  v_cndmask_b32 v28, v26, v27, s[72:73]
  s_nop 1
  v_add_f32_dpp v28, v28, v28 quad_perm:[1,0,3,2] row_mask:0xf bank_mask:0xf
  v_cvt_pk_bf16_f32 v28, v28, v28
  v_and_b32 v28, 0xffff0000, v28
  v_mul_f32 v28, s76, v28
  v_cvt_pk_bf16_f32 v28, v28, v28
  v_add_u32 v43, s25, v45
  ds_write_b16 v43, v28
  s_cmp_lg_u32 s35, 0
  s_cbranch_scc1 L_vent0
  s_branch L_kloop
L_vent0:
  ds_add_u32 v38, v39 offset:32
  s_branch L_v0
L_vent1:
  ds_add_u32 v38, v39 offset:32
  s_branch L_v1
.p2align 3
L_vloop:
L_v0:
  s_waitcnt lgkmcnt(0)
  s_add_u32 s36, s36, 4
  v_readfirstlane_b32 s34, v41
  v_readfirstlane_b32 s32, v40
  s_nop 0
  s_cmp_lt_u32 s36, s32
  s_cselect_b64 vcc, -1, 0
  s_nop 1
L_rV0:
  s_cmp_ge_u32 s36, s33
  s_cbranch_scc1 L_limV0
  s_and_b32 s79, s36, 63
  s_lshl_b32 s25, s79, 6
  s_lshr_b32 s70, s79, 2
  s_lshl_b32 s70, s70, 16
  s_add_u32 s70, s70, s69
  s_add_u32 s31, s70, 1048576
  v_add_u32 v43, s24, v45
  ds_read_u16 v28, v43
  s_cmp_ge_u32 s36, s37
  s_cbranch_scc1 L_b0
  s_cmp_lt_u32 s36, s34
  s_cbranch_vccnz L_thV0_0
  s_cbranch_scc0 L_tnV0_0
  s_waitcnt vmcnt(3)
L_tnV0_0:
  s_waitcnt vmcnt(4)
L_thV0_0:
  s_waitcnt vmcnt(6)
  buffer_load_dwordx4 v[80:83], v3, s[4:7], s70 offen offset:0 nt
  s_waitcnt lgkmcnt(0)
  v_lshlrev_b32 v28, 16, v28
  s_nop 1
  v_max_f32_dpp v34, v28, v28 row_ror:8 row_mask:0xf bank_mask:0xf
  s_nop 1
  v_max_f32_dpp v34, v34, v34 row_ror:4 row_mask:0xf bank_mask:0xf
  s_nop 1
  v_max_f32_dpp v34, v34, v34 row_ror:2 row_mask:0xf bank_mask:0xf
  v_max_f32 v34, v34, v29
  v_sub_f32 v33, v29, v34
  v_sub_f32 v28, v28, v34
  v_mul_f32 v33, s77, v33
  v_mul_f32 v28, s77, v28
  v_exp_f32 v33, v33
  v_exp_f32 v28, v28
  v_mov_b32 v29, v34
  v_cvt_pk_bf16_f32 v32, v28, v28
  v_mul_f32 v10, v10, v33
  v_mul_f32 v11, v11, v33
  v_mul_f32 v12, v12, v33
  v_mul_f32 v13, v13, v33
  v_mul_f32 v14, v14, v33
  v_mul_f32 v15, v15, v33
  v_mul_f32 v16, v16, v33
  v_mul_f32 v17, v17, v33
  v_and_b32 v31, 0xffff, v32
  v_and_b32 v32, 0xffff0000, v32
  s_nop 0
  v_dot2c_f32_bf16_dpp v10, v31, v48 row_newbcast:0 row_mask:0xf bank_mask:0xf
  v_dot2c_f32_bf16_dpp v11, v32, v48 row_newbcast:0 row_mask:0xf bank_mask:0xf
  v_dot2c_f32_bf16_dpp v12, v31, v49 row_newbcast:0 row_mask:0xf bank_mask:0xf
  v_dot2c_f32_bf16_dpp v13, v32, v49 row_newbcast:0 row_mask:0xf bank_mask:0xf
  v_dot2c_f32_bf16_dpp v14, v31, v50 row_newbcast:0 row_mask:0xf bank_mask:0xf
  v_dot2c_f32_bf16_dpp v15, v32, v50 row_newbcast:0 row_mask:0xf bank_mask:0xf
  v_dot2c_f32_bf16_dpp v16, v31, v51 row_newbcast:0 row_mask:0xf bank_mask:0xf
  v_dot2c_f32_bf16_dpp v17, v32, v51 row_newbcast:0 row_mask:0xf bank_mask:0xf
  s_nop 1
  s_cbranch_vccnz L_thV0_1
  s_cbranch_scc0 L_tnV0_1
  s_waitcnt vmcnt(3)
L_tnV0_1:
  s_waitcnt vmcnt(4)
L_thV0_1:
  s_waitcnt vmcnt(6)
  buffer_load_dwordx4 v[84:87], v3, s[4:7], s70 offen offset:1024 nt
  v_dot2c_f32_bf16_dpp v10, v31, v52 row_newbcast:8 row_mask:0xf bank_mask:0xf
  v_dot2c_f32_bf16_dpp v11, v32, v52 row_newbcast:8 row_mask:0xf bank_mask:0xf
  v_dot2c_f32_bf16_dpp v12, v31, v53 row_newbcast:8 row_mask:0xf bank_mask:0xf
  v_dot2c_f32_bf16_dpp v13, v32, v53 row_newbcast:8 row_mask:0xf bank_mask:0xf
  v_dot2c_f32_bf16_dpp v14, v31, v54 row_newbcast:8 row_mask:0xf bank_mask:0xf
  v_dot2c_f32_bf16_dpp v15, v32, v54 row_newbcast:8 row_mask:0xf bank_mask:0xf
  v_dot2c_f32_bf16_dpp v16, v31, v55 row_newbcast:8 row_mask:0xf bank_mask:0xf
  v_dot2c_f32_bf16_dpp v17, v32, v55 row_newbcast:8 row_mask:0xf bank_mask:0xf
  s_nop 1
  s_cbranch_vccnz L_thV0_2
  s_cbranch_scc0 L_tnV0_2
  s_waitcnt vmcnt(3)
L_tnV0_2:
  s_waitcnt vmcnt(4)
L_thV0_2:
  s_waitcnt vmcnt(6)
  buffer_load_dwordx4 v[88:91], v3, s[4:7], s70 offen offset:2048 nt
  v_dot2c_f32_bf16_dpp v10, v31, v56 row_newbcast:4 row_mask:0xf bank_mask:0xf
  v_dot2c_f32_bf16_dpp v11, v32, v56 row_newbcast:4 row_mask:0xf bank_mask:0xf
  v_dot2c_f32_bf16_dpp v12, v31, v57 row_newbcast:4 row_mask:0xf bank_mask:0xf
  v_dot2c_f32_bf16_dpp v13, v32, v57 row_newbcast:4 row_mask:0xf bank_mask:0xf
  v_dot2c_f32_bf16_dpp v14, v31, v58 row_newbcast:4 row_mask:0xf bank_mask:0xf
  v_dot2c_f32_bf16_dpp v15, v32, v58 row_newbcast:4 row_mask:0xf bank_mask:0xf
  v_dot2c_f32_bf16_dpp v16, v31, v59 row_newbcast:4 row_mask:0xf bank_mask:0xf
  v_dot2c_f32_bf16_dpp v17, v32, v59 row_newbcast:4 row_mask:0xf bank_mask:0xf
  s_nop 1
  s_cbranch_vccnz L_thV0_3
  s_cbranch_scc0 L_tnV0_3
  s_waitcnt vmcnt(3)
L_tnV0_3:
  s_waitcnt vmcnt(4)
L_thV0_3:
  s_waitcnt vmcnt(6)
  buffer_load_dwordx4 v[92:95], v3, s[4:7], s70 offen offset:3072 nt
  v_dot2c_f32_bf16_dpp v10, v31, v60 row_newbcast:12 row_mask:0xf bank_mask:0xf
  v_dot2c_f32_bf16_dpp v11, v32, v60 row_newbcast:12 row_mask:0xf bank_mask:0xf
  v_dot2c_f32_bf16_dpp v12, v31, v61 row_newbcast:12 row_mask:0xf bank_mask:0xf
  v_dot2c_f32_bf16_dpp v13, v32, v61 row_newbcast:12 row_mask:0xf bank_mask:0xf
  v_dot2c_f32_bf16_dpp v14, v31, v62 row_newbcast:12 row_mask:0xf bank_mask:0xf
  v_dot2c_f32_bf16_dpp v15, v32, v62 row_newbcast:12 row_mask:0xf bank_mask:0xf
  v_dot2c_f32_bf16_dpp v16, v31, v63 row_newbcast:12 row_mask:0xf bank_mask:0xf
  v_dot2c_f32_bf16_dpp v17, v32, v63 row_newbcast:12 row_mask:0xf bank_mask:0xf
  s_nop 1
  s_cbranch_vccnz L_thV0_4
  s_cbranch_scc0 L_tnV0_4
  s_waitcnt vmcnt(3)
L_tnV0_4:
  s_waitcnt vmcnt(4)
L_thV0_4:
  s_waitcnt vmcnt(6)
  buffer_load_dwordx4 v[96:99], v3, s[4:7], s31 offen offset:0 nt
  v_dot2c_f32_bf16_dpp v10, v31, v64 row_newbcast:2 row_mask:0xf bank_mask:0xf
  v_dot2c_f32_bf16_dpp v11, v32, v64 row_newbcast:2 row_mask:0xf bank_mask:0xf
  v_dot2c_f32_bf16_dpp v12, v31, v65 row_newbcast:2 row_mask:0xf bank_mask:0xf
  v_dot2c_f32_bf16_dpp v13, v32, v65 row_newbcast:2 row_mask:0xf bank_mask:0xf
  v_dot2c_f32_bf16_dpp v14, v31, v66 row_newbcast:2 row_mask:0xf bank_mask:0xf
  v_dot2c_f32_bf16_dpp v15, v32, v66 row_newbcast:2 row_mask:0xf bank_mask:0xf
  v_dot2c_f32_bf16_dpp v16, v31, v67 row_newbcast:2 row_mask:0xf bank_mask:0xf
  v_dot2c_f32_bf16_dpp v17, v32, v67 row_newbcast:2 row_mask:0xf bank_mask:0xf
  s_nop 1
  s_cbranch_vccnz L_thV0_5
  s_cbranch_scc0 L_tnV0_5
  s_waitcnt vmcnt(3)
L_tnV0_5:
  s_waitcnt vmcnt(4)
L_thV0_5:
  s_waitcnt vmcnt(6)
  buffer_load_dwordx4 v[100:103], v3, s[4:7], s31 offen offset:1024 nt
  v_dot2c_f32_bf16_dpp v10, v31, v68 row_newbcast:10 row_mask:0xf bank_mask:0xf
  v_dot2c_f32_bf16_dpp v11, v32, v68 row_newbcast:10 row_mask:0xf bank_mask:0xf
  v_dot2c_f32_bf16_dpp v12, v31, v69 row_newbcast:10 row_mask:0xf bank_mask:0xf
  v_dot2c_f32_bf16_dpp v13, v32, v69 row_newbcast:10 row_mask:0xf bank_mask:0xf
  v_dot2c_f32_bf16_dpp v14, v31, v70 row_newbcast:10 row_mask:0xf bank_mask:0xf
  v_dot2c_f32_bf16_dpp v15, v32, v70 row_newbcast:10 row_mask:0xf bank_mask:0xf
  v_dot2c_f32_bf16_dpp v16, v31, v71 row_newbcast:10 row_mask:0xf bank_mask:0xf
  v_dot2c_f32_bf16_dpp v17, v32, v71 row_newbcast:10 row_mask:0xf bank_mask:0xf
  s_nop 1
  s_cbranch_vccnz L_thV0_6
  s_cbranch_scc0 L_tnV0_6
  s_waitcnt vmcnt(3)
L_tnV0_6:
  s_waitcnt vmcnt(4)
L_thV0_6:
  s_waitcnt vmcnt(6)
  buffer_load_dwordx4 v[104:107], v3, s[4:7], s31 offen offset:2048 nt
  v_dot2c_f32_bf16_dpp v10, v31, v72 row_newbcast:6 row_mask:0xf bank_mask:0xf
  v_dot2c_f32_bf16_dpp v11, v32, v72 row_newbcast:6 row_mask:0xf bank_mask:0xf
  v_dot2c_f32_bf16_dpp v12, v31, v73 row_newbcast:6 row_mask:0xf bank_mask:0xf
  v_dot2c_f32_bf16_dpp v13, v32, v73 row_newbcast:6 row_mask:0xf bank_mask:0xf
  v_dot2c_f32_bf16_dpp v14, v31, v74 row_newbcast:6 row_mask:0xf bank_mask:0xf
  v_dot2c_f32_bf16_dpp v15, v32, v74 row_newbcast:6 row_mask:0xf bank_mask:0xf
  v_dot2c_f32_bf16_dpp v16, v31, v75 row_newbcast:6 row_mask:0xf bank_mask:0xf
  v_dot2c_f32_bf16_dpp v17, v32, v75 row_newbcast:6 row_mask:0xf bank_mask:0xf
  s_nop 1
  s_cbranch_vccnz L_thV0_7
  s_cbranch_scc0 L_tnV0_7
  s_waitcnt vmcnt(3)
L_tnV0_7:
  s_waitcnt vmcnt(4)
L_thV0_7:
  s_waitcnt vmcnt(6)
  buffer_load_dwordx4 v[108:111], v3, s[4:7], s31 offen offset:3072 nt
  s_mov_b64 exec, 1
  ds_add_u32 v38, v39 offset:0
  ds_read_b64 v[40:41], v38 offset:40
  s_mov_b64 exec, -1
  v_dot2c_f32_bf16_dpp v10, v31, v76 row_newbcast:14 row_mask:0xf bank_mask:0xf
  v_dot2c_f32_bf16_dpp v11, v32, v76 row_newbcast:14 row_mask:0xf bank_mask:0xf
  v_dot2c_f32_bf16_dpp v12, v31, v77 row_newbcast:14 row_mask:0xf bank_mask:0xf
  v_dot2c_f32_bf16_dpp v13, v32, v77 row_newbcast:14 row_mask:0xf bank_mask:0xf
  v_dot2c_f32_bf16_dpp v14, v31, v78 row_newbcast:14 row_mask:0xf bank_mask:0xf
  v_dot2c_f32_bf16_dpp v15, v32, v78 row_newbcast:14 row_mask:0xf bank_mask:0xf
  v_dot2c_f32_bf16_dpp v16, v31, v79 row_newbcast:14 row_mask:0xf bank_mask:0xf
  v_dot2c_f32_bf16_dpp v17, v32, v79 row_newbcast:14 row_mask:0xf bank_mask:0xf
  s_nop 2
L_v1:
  s_waitcnt lgkmcnt(0)
  s_add_u32 s36, s36, 4
  v_readfirstlane_b32 s34, v41
  v_readfirstlane_b32 s32, v40
  s_nop 0
  s_cmp_lt_u32 s36, s32
  s_cselect_b64 vcc, -1, 0
  s_nop 1
L_rV1:
  s_cmp_ge_u32 s36, s33
  s_cbranch_scc1 L_limV1
  s_and_b32 s79, s36, 63
  s_lshl_b32 s24, s79, 6
  s_lshr_b32 s70, s79, 2
  s_lshl_b32 s70, s70, 16
  s_add_u32 s70, s70, s69
  s_add_u32 s31, s70, 1048576
  v_add_u32 v43, s25, v45
  ds_read_u16 v28, v43
  s_cmp_ge_u32 s36, s37
  s_cbranch_scc1 L_b1
  s_cmp_lt_u32 s36, s34
  s_cbranch_vccnz L_thV1_0
  s_cbranch_scc0 L_tnV1_0
  s_waitcnt vmcnt(3)
L_tnV1_0:
  s_waitcnt vmcnt(4)
L_thV1_0:
  s_waitcnt vmcnt(6)
  buffer_load_dwordx4 v[48:51], v3, s[4:7], s70 offen offset:0 nt
  s_waitcnt lgkmcnt(0)
  v_lshlrev_b32 v28, 16, v28
  s_nop 1
  v_max_f32_dpp v34, v28, v28 row_ror:8 row_mask:0xf bank_mask:0xf
  s_nop 1
  v_max_f32_dpp v34, v34, v34 row_ror:4 row_mask:0xf bank_mask:0xf
  s_nop 1
  v_max_f32_dpp v34, v34, v34 row_ror:2 row_mask:0xf bank_mask:0xf
  v_max_f32 v34, v34, v29
  v_sub_f32 v33, v29, v34
  v_sub_f32 v28, v28, v34
  v_mul_f32 v33, s77, v33
  v_mul_f32 v28, s77, v28
  v_exp_f32 v33, v33
  v_exp_f32 v28, v28
  v_mov_b32 v29, v34
  v_cvt_pk_bf16_f32 v32, v28, v28
  v_mul_f32 v10, v10, v33
  v_mul_f32 v11, v11, v33
  v_mul_f32 v12, v12, v33
  v_mul_f32 v13, v13, v33
  v_mul_f32 v14, v14, v33
  v_mul_f32 v15, v15, v33
  v_mul_f32 v16, v16, v33
  v_mul_f32 v17, v17, v33
  v_and_b32 v31, 0xffff, v32
  v_and_b32 v32, 0xffff0000, v32
  s_nop 0
  v_dot2c_f32_bf16_dpp v10, v31, v80 row_newbcast:0 row_mask:0xf bank_mask:0xf
  v_dot2c_f32_bf16_dpp v11, v32, v80 row_newbcast:0 row_mask:0xf bank_mask:0xf
  v_dot2c_f32_bf16_dpp v12, v31, v81 row_newbcast:0 row_mask:0xf bank_mask:0xf
  v_dot2c_f32_bf16_dpp v13, v32, v81 row_newbcast:0 row_mask:0xf bank_mask:0xf
  v_dot2c_f32_bf16_dpp v14, v31, v82 row_newbcast:0 row_mask:0xf bank_mask:0xf
  v_dot2c_f32_bf16_dpp v15, v32, v82 row_newbcast:0 row_mask:0xf bank_mask:0xf
  v_dot2c_f32_bf16_dpp v16, v31, v83 row_newbcast:0 row_mask:0xf bank_mask:0xf
  v_dot2c_f32_bf16_dpp v17, v32, v83 row_newbcast:0 row_mask:0xf bank_mask:0xf
  s_nop 1
  s_cbranch_vccnz L_thV1_1
  s_cbranch_scc0 L_tnV1_1
  s_waitcnt vmcnt(3)
L_tnV1_1:
  s_waitcnt vmcnt(4)
L_thV1_1:
  s_waitcnt vmcnt(6)
  buffer_load_dwordx4 v[52:55], v3, s[4:7], s70 offen offset:1024 nt
  v_dot2c_f32_bf16_dpp v10, v31, v84 row_newbcast:8 row_mask:0xf bank_mask:0xf
  v_dot2c_f32_bf16_dpp v11, v32, v84 row_newbcast:8 row_mask:0xf bank_mask:0xf
  v_dot2c_f32_bf16_dpp v12, v31, v85 row_newbcast:8 row_mask:0xf bank_mask:0xf
  v_dot2c_f32_bf16_dpp v13, v32, v85 row_newbcast:8 row_mask:0xf bank_mask:0xf
  v_dot2c_f32_bf16_dpp v14, v31, v86 row_newbcast:8 row_mask:0xf bank_mask:0xf
  v_dot2c_f32_bf16_dpp v15, v32, v86 row_newbcast:8 row_mask:0xf bank_mask:0xf
  v_dot2c_f32_bf16_dpp v16, v31, v87 row_newbcast:8 row_mask:0xf bank_mask:0xf
  v_dot2c_f32_bf16_dpp v17, v32, v87 row_newbcast:8 row_mask:0xf bank_mask:0xf
  s_nop 1
  s_cbranch_vccnz L_thV1_2
  s_cbranch_scc0 L_tnV1_2
  s_waitcnt vmcnt(3)
L_tnV1_2:
  s_waitcnt vmcnt(4)
L_thV1_2:
  s_waitcnt vmcnt(6)
  buffer_load_dwordx4 v[56:59], v3, s[4:7], s70 offen offset:2048 nt
  v_dot2c_f32_bf16_dpp v10, v31, v88 row_newbcast:4 row_mask:0xf bank_mask:0xf
  v_dot2c_f32_bf16_dpp v11, v32, v88 row_newbcast:4 row_mask:0xf bank_mask:0xf
  v_dot2c_f32_bf16_dpp v12, v31, v89 row_newbcast:4 row_mask:0xf bank_mask:0xf
  v_dot2c_f32_bf16_dpp v13, v32, v89 row_newbcast:4 row_mask:0xf bank_mask:0xf
  v_dot2c_f32_bf16_dpp v14, v31, v90 row_newbcast:4 row_mask:0xf bank_mask:0xf
  v_dot2c_f32_bf16_dpp v15, v32, v90 row_newbcast:4 row_mask:0xf bank_mask:0xf
  v_dot2c_f32_bf16_dpp v16, v31, v91 row_newbcast:4 row_mask:0xf bank_mask:0xf
  v_dot2c_f32_bf16_dpp v17, v32, v91 row_newbcast:4 row_mask:0xf bank_mask:0xf
  s_nop 1
  s_cbranch_vccnz L_thV1_3
  s_cbranch_scc0 L_tnV1_3
  s_waitcnt vmcnt(3)
L_tnV1_3:
  s_waitcnt vmcnt(4)
L_thV1_3:
  s_waitcnt vmcnt(6)
  buffer_load_dwordx4 v[60:63], v3, s[4:7], s70 offen offset:3072 nt
  v_dot2c_f32_bf16_dpp v10, v31, v92 row_newbcast:12 row_mask:0xf bank_mask:0xf
  v_dot2c_f32_bf16_dpp v11, v32, v92 row_newbcast:12 row_mask:0xf bank_mask:0xf
  v_dot2c_f32_bf16_dpp v12, v31, v93 row_newbcast:12 row_mask:0xf bank_mask:0xf
  v_dot2c_f32_bf16_dpp v13, v32, v93 row_newbcast:12 row_mask:0xf bank_mask:0xf
  v_dot2c_f32_bf16_dpp v14, v31, v94 row_newbcast:12 row_mask:0xf bank_mask:0xf
  v_dot2c_f32_bf16_dpp v15, v32, v94 row_newbcast:12 row_mask:0xf bank_mask:0xf
  v_dot2c_f32_bf16_dpp v16, v31, v95 row_newbcast:12 row_mask:0xf bank_mask:0xf
  v_dot2c_f32_bf16_dpp v17, v32, v95 row_newbcast:12 row_mask:0xf bank_mask:0xf
  s_nop 1
  s_cbranch_vccnz L_thV1_4
  s_cbranch_scc0 L_tnV1_4
  s_waitcnt vmcnt(3)
L_tnV1_4:
  s_waitcnt vmcnt(4)
L_thV1_4:
  s_waitcnt vmcnt(6)
  buffer_load_dwordx4 v[64:67], v3, s[4:7], s31 offen offset:0 nt
  v_dot2c_f32_bf16_dpp v10, v31, v96 row_newbcast:2 row_mask:0xf bank_mask:0xf
  v_dot2c_f32_bf16_dpp v11, v32, v96 row_newbcast:2 row_mask:0xf bank_mask:0xf
  v_dot2c_f32_bf16_dpp v12, v31, v97 row_newbcast:2 row_mask:0xf bank_mask:0xf
  v_dot2c_f32_bf16_dpp v13, v32, v97 row_newbcast:2 row_mask:0xf bank_mask:0xf
  v_dot2c_f32_bf16_dpp v14, v31, v98 row_newbcast:2 row_mask:0xf bank_mask:0xf
  v_dot2c_f32_bf16_dpp v15, v32, v98 row_newbcast:2 row_mask:0xf bank_mask:0xf
  v_dot2c_f32_bf16_dpp v16, v31, v99 row_newbcast:2 row_mask:0xf bank_mask:0xf
  v_dot2c_f32_bf16_dpp v17, v32, v99 row_newbcast:2 row_mask:0xf bank_mask:0xf
  s_nop 1
  s_cbranch_vccnz L_thV1_5
  s_cbranch_scc0 L_tnV1_5
  s_waitcnt vmcnt(3)
L_tnV1_5:
  s_waitcnt vmcnt(4)
L_thV1_5:
  s_waitcnt vmcnt(6)
  buffer_load_dwordx4 v[68:71], v3, s[4:7], s31 offen offset:1024 nt
  v_dot2c_f32_bf16_dpp v10, v31, v100 row_newbcast:10 row_mask:0xf bank_mask:0xf
  v_dot2c_f32_bf16_dpp v11, v32, v100 row_newbcast:10 row_mask:0xf bank_mask:0xf
  v_dot2c_f32_bf16_dpp v12, v31, v101 row_newbcast:10 row_mask:0xf bank_mask:0xf
  v_dot2c_f32_bf16_dpp v13, v32, v101 row_newbcast:10 row_mask:0xf bank_mask:0xf
  v_dot2c_f32_bf16_dpp v14, v31, v102 row_newbcast:10 row_mask:0xf bank_mask:0xf
  v_dot2c_f32_bf16_dpp v15, v32, v102 row_newbcast:10 row_mask:0xf bank_mask:0xf
  v_dot2c_f32_bf16_dpp v16, v31, v103 row_newbcast:10 row_mask:0xf bank_mask:0xf
  v_dot2c_f32_bf16_dpp v17, v32, v103 row_newbcast:10 row_mask:0xf bank_mask:0xf
  s_nop 1
  s_cbranch_vccnz L_thV1_6
  s_cbranch_scc0 L_tnV1_6
  s_waitcnt vmcnt(3)
L_tnV1_6:
  s_waitcnt vmcnt(4)
L_thV1_6:
  s_waitcnt vmcnt(6)
  buffer_load_dwordx4 v[72:75], v3, s[4:7], s31 offen offset:2048 nt
  v_dot2c_f32_bf16_dpp v10, v31, v104 row_newbcast:6 row_mask:0xf bank_mask:0xf
  v_dot2c_f32_bf16_dpp v11, v32, v104 row_newbcast:6 row_mask:0xf bank_mask:0xf
  v_dot2c_f32_bf16_dpp v12, v31, v105 row_newbcast:6 row_mask:0xf bank_mask:0xf
  v_dot2c_f32_bf16_dpp v13, v32, v105 row_newbcast:6 row_mask:0xf bank_mask:0xf
  v_dot2c_f32_bf16_dpp v14, v31, v106 row_newbcast:6 row_mask:0xf bank_mask:0xf
  v_dot2c_f32_bf16_dpp v15, v32, v106 row_newbcast:6 row_mask:0xf bank_mask:0xf
  v_dot2c_f32_bf16_dpp v16, v31, v107 row_newbcast:6 row_mask:0xf bank_mask:0xf
  v_dot2c_f32_bf16_dpp v17, v32, v107 row_newbcast:6 row_mask:0xf bank_mask:0xf
  s_nop 1
  s_cbranch_vccnz L_thV1_7
  s_cbranch_scc0 L_tnV1_7
  s_waitcnt vmcnt(3)
L_tnV1_7:
  s_waitcnt vmcnt(4)
L_thV1_7:
  s_waitcnt vmcnt(6)
  buffer_load_dwordx4 v[76:79], v3, s[4:7], s31 offen offset:3072 nt
  s_mov_b64 exec, 1
  ds_add_u32 v38, v39 offset:0
  ds_read_b64 v[40:41], v38 offset:40
  s_mov_b64 exec, -1
  v_dot2c_f32_bf16_dpp v10, v31, v108 row_newbcast:14 row_mask:0xf bank_mask:0xf
  v_dot2c_f32_bf16_dpp v11, v32, v108 row_newbcast:14 row_mask:0xf bank_mask:0xf
  v_dot2c_f32_bf16_dpp v12, v31, v109 row_newbcast:14 row_mask:0xf bank_mask:0xf
  v_dot2c_f32_bf16_dpp v13, v32, v109 row_newbcast:14 row_mask:0xf bank_mask:0xf
  v_dot2c_f32_bf16_dpp v14, v31, v110 row_newbcast:14 row_mask:0xf bank_mask:0xf
  v_dot2c_f32_bf16_dpp v15, v32, v110 row_newbcast:14 row_mask:0xf bank_mask:0xf
  v_dot2c_f32_bf16_dpp v16, v31, v111 row_newbcast:14 row_mask:0xf bank_mask:0xf
  v_dot2c_f32_bf16_dpp v17, v32, v111 row_newbcast:14 row_mask:0xf bank_mask:0xf
  s_nop 1
  s_branch L_vloop
L_b0:
  buffer_load_dwordx4 v[80:83], v3, s[4:7], s70 offen offset:0 nt
  buffer_load_dwordx4 v[84:87], v3, s[4:7], s70 offen offset:1024 nt
  buffer_load_dwordx4 v[88:91], v3, s[4:7], s70 offen offset:2048 nt
  buffer_load_dwordx4 v[92:95], v3, s[4:7], s70 offen offset:3072 nt
  buffer_load_dwordx4 v[96:99], v3, s[4:7], s31 offen offset:0 nt
  buffer_load_dwordx4 v[100:103], v3, s[4:7], s31 offen offset:1024 nt
  buffer_load_dwordx4 v[104:107], v3, s[4:7], s31 offen offset:2048 nt
  buffer_load_dwordx4 v[108:111], v3, s[4:7], s31 offen offset:3072 nt
  s_waitcnt lgkmcnt(0)
  v_lshlrev_b32 v28, 16, v28
  s_nop 1
  v_max_f32_dpp v34, v28, v28 row_ror:8 row_mask:0xf bank_mask:0xf
  s_nop 1
  v_max_f32_dpp v34, v34, v34 row_ror:4 row_mask:0xf bank_mask:0xf
  s_nop 1
  v_max_f32_dpp v34, v34, v34 row_ror:2 row_mask:0xf bank_mask:0xf
  v_max_f32 v34, v34, v29
  v_sub_f32 v33, v29, v34
  v_sub_f32 v28, v28, v34
  v_mul_f32 v33, s77, v33
  v_mul_f32 v28, s77, v28
  v_exp_f32 v33, v33
  v_exp_f32 v28, v28
  v_mov_b32 v29, v34
  v_cvt_pk_bf16_f32 v32, v28, v28
  v_mul_f32 v10, v10, v33
  v_mul_f32 v11, v11, v33
  v_mul_f32 v12, v12, v33
  v_mul_f32 v13, v13, v33
  v_mul_f32 v14, v14, v33
  v_mul_f32 v15, v15, v33
  v_mul_f32 v16, v16, v33
  v_mul_f32 v17, v17, v33
  v_and_b32 v31, 0xffff, v32
  v_and_b32 v32, 0xffff0000, v32
  s_waitcnt vmcnt(15)
  v_dot2c_f32_bf16_dpp v10, v31, v48 row_newbcast:0 row_mask:0xf bank_mask:0xf
  v_dot2c_f32_bf16_dpp v11, v32, v48 row_newbcast:0 row_mask:0xf bank_mask:0xf
  v_dot2c_f32_bf16_dpp v12, v31, v49 row_newbcast:0 row_mask:0xf bank_mask:0xf
  v_dot2c_f32_bf16_dpp v13, v32, v49 row_newbcast:0 row_mask:0xf bank_mask:0xf
  v_dot2c_f32_bf16_dpp v14, v31, v50 row_newbcast:0 row_mask:0xf bank_mask:0xf
  v_dot2c_f32_bf16_dpp v15, v32, v50 row_newbcast:0 row_mask:0xf bank_mask:0xf
  v_dot2c_f32_bf16_dpp v16, v31, v51 row_newbcast:0 row_mask:0xf bank_mask:0xf
  v_dot2c_f32_bf16_dpp v17, v32, v51 row_newbcast:0 row_mask:0xf bank_mask:0xf
  s_waitcnt vmcnt(14)
  v_dot2c_f32_bf16_dpp v10, v31, v52 row_newbcast:8 row_mask:0xf bank_mask:0xf
  v_dot2c_f32_bf16_dpp v11, v32, v52 row_newbcast:8 row_mask:0xf bank_mask:0xf
  v_dot2c_f32_bf16_dpp v12, v31, v53 row_newbcast:8 row_mask:0xf bank_mask:0xf
  v_dot2c_f32_bf16_dpp v13, v32, v53 row_newbcast:8 row_mask:0xf bank_mask:0xf
  v_dot2c_f32_bf16_dpp v14, v31, v54 row_newbcast:8 row_mask:0xf bank_mask:0xf
  v_dot2c_f32_bf16_dpp v15, v32, v54 row_newbcast:8 row_mask:0xf bank_mask:0xf
  v_dot2c_f32_bf16_dpp v16, v31, v55 row_newbcast:8 row_mask:0xf bank_mask:0xf
  v_dot2c_f32_bf16_dpp v17, v32, v55 row_newbcast:8 row_mask:0xf bank_mask:0xf
  s_waitcnt vmcnt(13)
  v_dot2c_f32_bf16_dpp v10, v31, v56 row_newbcast:4 row_mask:0xf bank_mask:0xf
  v_dot2c_f32_bf16_dpp v11, v32, v56 row_newbcast:4 row_mask:0xf bank_mask:0xf
  v_dot2c_f32_bf16_dpp v12, v31, v57 row_newbcast:4 row_mask:0xf bank_mask:0xf
  v_dot2c_f32_bf16_dpp v13, v32, v57 row_newbcast:4 row_mask:0xf bank_mask:0xf
  v_dot2c_f32_bf16_dpp v14, v31, v58 row_newbcast:4 row_mask:0xf bank_mask:0xf
  v_dot2c_f32_bf16_dpp v15, v32, v58 row_newbcast:4 row_mask:0xf bank_mask:0xf
  v_dot2c_f32_bf16_dpp v16, v31, v59 row_newbcast:4 row_mask:0xf bank_mask:0xf
  v_dot2c_f32_bf16_dpp v17, v32, v59 row_newbcast:4 row_mask:0xf bank_mask:0xf
  s_waitcnt vmcnt(12)
  v_dot2c_f32_bf16_dpp v10, v31, v60 row_newbcast:12 row_mask:0xf bank_mask:0xf
  v_dot2c_f32_bf16_dpp v11, v32, v60 row_newbcast:12 row_mask:0xf bank_mask:0xf
  v_dot2c_f32_bf16_dpp v12, v31, v61 row_newbcast:12 row_mask:0xf bank_mask:0xf
  v_dot2c_f32_bf16_dpp v13, v32, v61 row_newbcast:12 row_mask:0xf bank_mask:0xf
  v_dot2c_f32_bf16_dpp v14, v31, v62 row_newbcast:12 row_mask:0xf bank_mask:0xf
  v_dot2c_f32_bf16_dpp v15, v32, v62 row_newbcast:12 row_mask:0xf bank_mask:0xf
  v_dot2c_f32_bf16_dpp v16, v31, v63 row_newbcast:12 row_mask:0xf bank_mask:0xf
  v_dot2c_f32_bf16_dpp v17, v32, v63 row_newbcast:12 row_mask:0xf bank_mask:0xf
  s_waitcnt vmcnt(11)
  v_dot2c_f32_bf16_dpp v10, v31, v64 row_newbcast:2 row_mask:0xf bank_mask:0xf
  v_dot2c_f32_bf16_dpp v11, v32, v64 row_newbcast:2 row_mask:0xf bank_mask:0xf
  v_dot2c_f32_bf16_dpp v12, v31, v65 row_newbcast:2 row_mask:0xf bank_mask:0xf
  v_dot2c_f32_bf16_dpp v13, v32, v65 row_newbcast:2 row_mask:0xf bank_mask:0xf
  v_dot2c_f32_bf16_dpp v14, v31, v66 row_newbcast:2 row_mask:0xf bank_mask:0xf
  v_dot2c_f32_bf16_dpp v15, v32, v66 row_newbcast:2 row_mask:0xf bank_mask:0xf
  v_dot2c_f32_bf16_dpp v16, v31, v67 row_newbcast:2 row_mask:0xf bank_mask:0xf
  v_dot2c_f32_bf16_dpp v17, v32, v67 row_newbcast:2 row_mask:0xf bank_mask:0xf
  s_waitcnt vmcnt(10)
  v_dot2c_f32_bf16_dpp v10, v31, v68 row_newbcast:10 row_mask:0xf bank_mask:0xf
  v_dot2c_f32_bf16_dpp v11, v32, v68 row_newbcast:10 row_mask:0xf bank_mask:0xf
  v_dot2c_f32_bf16_dpp v12, v31, v69 row_newbcast:10 row_mask:0xf bank_mask:0xf
  v_dot2c_f32_bf16_dpp v13, v32, v69 row_newbcast:10 row_mask:0xf bank_mask:0xf
  v_dot2c_f32_bf16_dpp v14, v31, v70 row_newbcast:10 row_mask:0xf bank_mask:0xf
  v_dot2c_f32_bf16_dpp v15, v32, v70 row_newbcast:10 row_mask:0xf bank_mask:0xf
  v_dot2c_f32_bf16_dpp v16, v31, v71 row_newbcast:10 row_mask:0xf bank_mask:0xf
  v_dot2c_f32_bf16_dpp v17, v32, v71 row_newbcast:10 row_mask:0xf bank_mask:0xf
  s_waitcnt vmcnt(9)
  v_dot2c_f32_bf16_dpp v10, v31, v72 row_newbcast:6 row_mask:0xf bank_mask:0xf
  v_dot2c_f32_bf16_dpp v11, v32, v72 row_newbcast:6 row_mask:0xf bank_mask:0xf
  v_dot2c_f32_bf16_dpp v12, v31, v73 row_newbcast:6 row_mask:0xf bank_mask:0xf
  v_dot2c_f32_bf16_dpp v13, v32, v73 row_newbcast:6 row_mask:0xf bank_mask:0xf
  v_dot2c_f32_bf16_dpp v14, v31, v74 row_newbcast:6 row_mask:0xf bank_mask:0xf
  v_dot2c_f32_bf16_dpp v15, v32, v74 row_newbcast:6 row_mask:0xf bank_mask:0xf
  v_dot2c_f32_bf16_dpp v16, v31, v75 row_newbcast:6 row_mask:0xf bank_mask:0xf
  v_dot2c_f32_bf16_dpp v17, v32, v75 row_newbcast:6 row_mask:0xf bank_mask:0xf
  s_waitcnt vmcnt(8)
  s_mov_b64 exec, 1
  ds_add_u32 v38, v39 offset:0
  ds_read_b64 v[40:41], v38 offset:40
  s_mov_b64 exec, -1
  v_dot2c_f32_bf16_dpp v10, v31, v76 row_newbcast:14 row_mask:0xf bank_mask:0xf
  v_dot2c_f32_bf16_dpp v11, v32, v76 row_newbcast:14 row_mask:0xf bank_mask:0xf
  v_dot2c_f32_bf16_dpp v12, v31, v77 row_newbcast:14 row_mask:0xf bank_mask:0xf
  v_dot2c_f32_bf16_dpp v13, v32, v77 row_newbcast:14 row_mask:0xf bank_mask:0xf
  v_dot2c_f32_bf16_dpp v14, v31, v78 row_newbcast:14 row_mask:0xf bank_mask:0xf
  v_dot2c_f32_bf16_dpp v15, v32, v78 row_newbcast:14 row_mask:0xf bank_mask:0xf
  v_dot2c_f32_bf16_dpp v16, v31, v79 row_newbcast:14 row_mask:0xf bank_mask:0xf
  v_dot2c_f32_bf16_dpp v17, v32, v79 row_newbcast:14 row_mask:0xf bank_mask:0xf
  s_nop 1
  s_branch L_v1
L_b1:
  buffer_load_dwordx4 v[48:51], v3, s[4:7], s70 offen offset:0 nt
  buffer_load_dwordx4 v[52:55], v3, s[4:7], s70 offen offset:1024 nt
  buffer_load_dwordx4 v[56:59], v3, s[4:7], s70 offen offset:2048 nt
  buffer_load_dwordx4 v[60:63], v3, s[4:7], s70 offen offset:3072 nt
  buffer_load_dwordx4 v[64:67], v3, s[4:7], s31 offen offset:0 nt
  buffer_load_dwordx4 v[68:71], v3, s[4:7], s31 offen offset:1024 nt
  buffer_load_dwordx4 v[72:75], v3, s[4:7], s31 offen offset:2048 nt
  buffer_load_dwordx4 v[76:79], v3, s[4:7], s31 offen offset:3072 nt
  s_waitcnt lgkmcnt(0)
  v_lshlrev_b32 v28, 16, v28
  s_nop 1
  v_max_f32_dpp v34, v28, v28 row_ror:8 row_mask:0xf bank_mask:0xf
  s_nop 1
  v_max_f32_dpp v34, v34, v34 row_ror:4 row_mask:0xf bank_mask:0xf
  s_nop 1
  v_max_f32_dpp v34, v34, v34 row_ror:2 row_mask:0xf bank_mask:0xf
  v_max_f32 v34, v34, v29
  v_sub_f32 v33, v29, v34
  v_sub_f32 v28, v28, v34
  v_mul_f32 v33, s77, v33
  v_mul_f32 v28, s77, v28
  v_exp_f32 v33, v33
  v_exp_f32 v28, v28
  v_mov_b32 v29, v34
  v_cvt_pk_bf16_f32 v32, v28, v28
  v_mul_f32 v10, v10, v33
  v_mul_f32 v11, v11, v33
  v_mul_f32 v12, v12, v33
  v_mul_f32 v13, v13, v33
  v_mul_f32 v14, v14, v33
  v_mul_f32 v15, v15, v33
  v_mul_f32 v16, v16, v33
  v_mul_f32 v17, v17, v33
  v_and_b32 v31, 0xffff, v32
  v_and_b32 v32, 0xffff0000, v32
  s_waitcnt vmcnt(15)
  v_dot2c_f32_bf16_dpp v10, v31, v80 row_newbcast:0 row_mask:0xf bank_mask:0xf
  v_dot2c_f32_bf16_dpp v11, v32, v80 row_newbcast:0 row_mask:0xf bank_mask:0xf
  v_dot2c_f32_bf16_dpp v12, v31, v81 row_newbcast:0 row_mask:0xf bank_mask:0xf
  v_dot2c_f32_bf16_dpp v13, v32, v81 row_newbcast:0 row_mask:0xf bank_mask:0xf
  v_dot2c_f32_bf16_dpp v14, v31, v82 row_newbcast:0 row_mask:0xf bank_mask:0xf
  v_dot2c_f32_bf16_dpp v15, v32, v82 row_newbcast:0 row_mask:0xf bank_mask:0xf
  v_dot2c_f32_bf16_dpp v16, v31, v83 row_newbcast:0 row_mask:0xf bank_mask:0xf
  v_dot2c_f32_bf16_dpp v17, v32, v83 row_newbcast:0 row_mask:0xf bank_mask:0xf
  s_waitcnt vmcnt(14)
  v_dot2c_f32_bf16_dpp v10, v31, v84 row_newbcast:8 row_mask:0xf bank_mask:0xf
  v_dot2c_f32_bf16_dpp v11, v32, v84 row_newbcast:8 row_mask:0xf bank_mask:0xf
  v_dot2c_f32_bf16_dpp v12, v31, v85 row_newbcast:8 row_mask:0xf bank_mask:0xf
  v_dot2c_f32_bf16_dpp v13, v32, v85 row_newbcast:8 row_mask:0xf bank_mask:0xf
  v_dot2c_f32_bf16_dpp v14, v31, v86 row_newbcast:8 row_mask:0xf bank_mask:0xf
  v_dot2c_f32_bf16_dpp v15, v32, v86 row_newbcast:8 row_mask:0xf bank_mask:0xf
  v_dot2c_f32_bf16_dpp v16, v31, v87 row_newbcast:8 row_mask:0xf bank_mask:0xf
  v_dot2c_f32_bf16_dpp v17, v32, v87 row_newbcast:8 row_mask:0xf bank_mask:0xf
  s_waitcnt vmcnt(13)
  v_dot2c_f32_bf16_dpp v10, v31, v88 row_newbcast:4 row_mask:0xf bank_mask:0xf
  v_dot2c_f32_bf16_dpp v11, v32, v88 row_newbcast:4 row_mask:0xf bank_mask:0xf
  v_dot2c_f32_bf16_dpp v12, v31, v89 row_newbcast:4 row_mask:0xf bank_mask:0xf
  v_dot2c_f32_bf16_dpp v13, v32, v89 row_newbcast:4 row_mask:0xf bank_mask:0xf
  v_dot2c_f32_bf16_dpp v14, v31, v90 row_newbcast:4 row_mask:0xf bank_mask:0xf
  v_dot2c_f32_bf16_dpp v15, v32, v90 row_newbcast:4 row_mask:0xf bank_mask:0xf
  v_dot2c_f32_bf16_dpp v16, v31, v91 row_newbcast:4 row_mask:0xf bank_mask:0xf
  v_dot2c_f32_bf16_dpp v17, v32, v91 row_newbcast:4 row_mask:0xf bank_mask:0xf
  s_waitcnt vmcnt(12)
  v_dot2c_f32_bf16_dpp v10, v31, v92 row_newbcast:12 row_mask:0xf bank_mask:0xf
  v_dot2c_f32_bf16_dpp v11, v32, v92 row_newbcast:12 row_mask:0xf bank_mask:0xf
  v_dot2c_f32_bf16_dpp v12, v31, v93 row_newbcast:12 row_mask:0xf bank_mask:0xf
  v_dot2c_f32_bf16_dpp v13, v32, v93 row_newbcast:12 row_mask:0xf bank_mask:0xf
  v_dot2c_f32_bf16_dpp v14, v31, v94 row_newbcast:12 row_mask:0xf bank_mask:0xf
  v_dot2c_f32_bf16_dpp v15, v32, v94 row_newbcast:12 row_mask:0xf bank_mask:0xf
  v_dot2c_f32_bf16_dpp v16, v31, v95 row_newbcast:12 row_mask:0xf bank_mask:0xf
  v_dot2c_f32_bf16_dpp v17, v32, v95 row_newbcast:12 row_mask:0xf bank_mask:0xf
  s_waitcnt vmcnt(11)
  v_dot2c_f32_bf16_dpp v10, v31, v96 row_newbcast:2 row_mask:0xf bank_mask:0xf
  v_dot2c_f32_bf16_dpp v11, v32, v96 row_newbcast:2 row_mask:0xf bank_mask:0xf
  v_dot2c_f32_bf16_dpp v12, v31, v97 row_newbcast:2 row_mask:0xf bank_mask:0xf
  v_dot2c_f32_bf16_dpp v13, v32, v97 row_newbcast:2 row_mask:0xf bank_mask:0xf
  v_dot2c_f32_bf16_dpp v14, v31, v98 row_newbcast:2 row_mask:0xf bank_mask:0xf
  v_dot2c_f32_bf16_dpp v15, v32, v98 row_newbcast:2 row_mask:0xf bank_mask:0xf
  v_dot2c_f32_bf16_dpp v16, v31, v99 row_newbcast:2 row_mask:0xf bank_mask:0xf
  v_dot2c_f32_bf16_dpp v17, v32, v99 row_newbcast:2 row_mask:0xf bank_mask:0xf
  s_waitcnt vmcnt(10)
  v_dot2c_f32_bf16_dpp v10, v31, v100 row_newbcast:10 row_mask:0xf bank_mask:0xf
  v_dot2c_f32_bf16_dpp v11, v32, v100 row_newbcast:10 row_mask:0xf bank_mask:0xf
  v_dot2c_f32_bf16_dpp v12, v31, v101 row_newbcast:10 row_mask:0xf bank_mask:0xf
  v_dot2c_f32_bf16_dpp v13, v32, v101 row_newbcast:10 row_mask:0xf bank_mask:0xf
  v_dot2c_f32_bf16_dpp v14, v31, v102 row_newbcast:10 row_mask:0xf bank_mask:0xf
  v_dot2c_f32_bf16_dpp v15, v32, v102 row_newbcast:10 row_mask:0xf bank_mask:0xf
  v_dot2c_f32_bf16_dpp v16, v31, v103 row_newbcast:10 row_mask:0xf bank_mask:0xf
  v_dot2c_f32_bf16_dpp v17, v32, v103 row_newbcast:10 row_mask:0xf bank_mask:0xf
  s_waitcnt vmcnt(9)
  v_dot2c_f32_bf16_dpp v10, v31, v104 row_newbcast:6 row_mask:0xf bank_mask:0xf
  v_dot2c_f32_bf16_dpp v11, v32, v104 row_newbcast:6 row_mask:0xf bank_mask:0xf
  v_dot2c_f32_bf16_dpp v12, v31, v105 row_newbcast:6 row_mask:0xf bank_mask:0xf
  v_dot2c_f32_bf16_dpp v13, v32, v105 row_newbcast:6 row_mask:0xf bank_mask:0xf
  v_dot2c_f32_bf16_dpp v14, v31, v106 row_newbcast:6 row_mask:0xf bank_mask:0xf
  v_dot2c_f32_bf16_dpp v15, v32, v106 row_newbcast:6 row_mask:0xf bank_mask:0xf
  v_dot2c_f32_bf16_dpp v16, v31, v107 row_newbcast:6 row_mask:0xf bank_mask:0xf
  v_dot2c_f32_bf16_dpp v17, v32, v107 row_newbcast:6 row_mask:0xf bank_mask:0xf
  s_waitcnt vmcnt(8)
  s_mov_b64 exec, 1
  ds_add_u32 v38, v39 offset:0
  ds_read_b64 v[40:41], v38 offset:40
  s_mov_b64 exec, -1
  v_dot2c_f32_bf16_dpp v10, v31, v108 row_newbcast:14 row_mask:0xf bank_mask:0xf
  v_dot2c_f32_bf16_dpp v11, v32, v108 row_newbcast:14 row_mask:0xf bank_mask:0xf
  v_dot2c_f32_bf16_dpp v12, v31, v109 row_newbcast:14 row_mask:0xf bank_mask:0xf
  v_dot2c_f32_bf16_dpp v13, v32, v109 row_newbcast:14 row_mask:0xf bank_mask:0xf
  v_dot2c_f32_bf16_dpp v14, v31, v110 row_newbcast:14 row_mask:0xf bank_mask:0xf
  v_dot2c_f32_bf16_dpp v15, v32, v110 row_newbcast:14 row_mask:0xf bank_mask:0xf
  v_dot2c_f32_bf16_dpp v16, v31, v111 row_newbcast:14 row_mask:0xf bank_mask:0xf
  v_dot2c_f32_bf16_dpp v17, v32, v111 row_newbcast:14 row_mask:0xf bank_mask:0xf
  s_nop 1
  s_branch L_v0
L_limK0:
  s_mov_b32 s4, s44
  s_mov_b32 s5, s45
  s_mov_b32 s33, 112
  s_mov_b32 s35, 2
  s_branch L_rK0
L_limK1:
  s_mov_b32 s4, s44
  s_mov_b32 s5, s45
  s_mov_b32 s33, 112
  s_mov_b32 s35, 2
  s_branch L_rK1
L_limV0:
  s_cmp_lg_u32 s35, 2
  s_cbranch_scc1 L_drainV0
  s_mov_b32 s78, 0
L_lw0:
  ds_read_b32 v43, v38 offset:16
  s_waitcnt lgkmcnt(0)
  v_readfirstlane_b32 s79, v43
  s_nop 0
  s_cmp_ge_u32 s79, 1
  s_nop 1
  s_cbranch_scc1 L_lwd0
  s_add_u32 s78, s78, 1
  s_cmp_gt_u32 s78, 0x400000
  s_cbranch_scc1 L_end
  s_sleep 2
  s_branch L_lw0
L_lwd0:
  ds_read_b64 v[46:47], v38 offset:24
  s_mov_b32 s33, 128
  s_mov_b32 s35, 3
  s_mov_b32 s37, 124
  s_waitcnt lgkmcnt(0)
  s_branch L_rV0
L_drainV0:
  v_add_u32 v43, s24, v45
  ds_read_u16 v28, v43
  v_sub_f32 v33, v29, v46
  v_mul_f32 v33, s77, v33
  v_exp_f32 v33, v33
  s_waitcnt lgkmcnt(0)
  v_lshlrev_b32 v28, 16, v28
  v_sub_f32 v28, v28, v46
  v_mul_f32 v28, s77, v28
  v_exp_f32 v28, v28
  v_mul_f32 v33, v33, v47
  v_mul_f32 v28, v28, v47
  v_cvt_pk_bf16_f32 v32, v28, v28
  v_mul_f32 v10, v10, v33
  v_mul_f32 v11, v11, v33
  v_mul_f32 v12, v12, v33
  v_mul_f32 v13, v13, v33
  v_mul_f32 v14, v14, v33
  v_mul_f32 v15, v15, v33
  v_mul_f32 v16, v16, v33
  v_mul_f32 v17, v17, v33
  v_and_b32 v31, 0xffff, v32
  v_and_b32 v32, 0xffff0000, v32
  s_waitcnt vmcnt(7)
  v_dot2c_f32_bf16_dpp v10, v31, v48 row_newbcast:0 row_mask:0xf bank_mask:0xf
  v_dot2c_f32_bf16_dpp v11, v32, v48 row_newbcast:0 row_mask:0xf bank_mask:0xf
  v_dot2c_f32_bf16_dpp v12, v31, v49 row_newbcast:0 row_mask:0xf bank_mask:0xf
  v_dot2c_f32_bf16_dpp v13, v32, v49 row_newbcast:0 row_mask:0xf bank_mask:0xf
  v_dot2c_f32_bf16_dpp v14, v31, v50 row_newbcast:0 row_mask:0xf bank_mask:0xf
  v_dot2c_f32_bf16_dpp v15, v32, v50 row_newbcast:0 row_mask:0xf bank_mask:0xf
  v_dot2c_f32_bf16_dpp v16, v31, v51 row_newbcast:0 row_mask:0xf bank_mask:0xf
  v_dot2c_f32_bf16_dpp v17, v32, v51 row_newbcast:0 row_mask:0xf bank_mask:0xf
  s_waitcnt vmcnt(6)
  v_dot2c_f32_bf16_dpp v10, v31, v52 row_newbcast:8 row_mask:0xf bank_mask:0xf
  v_dot2c_f32_bf16_dpp v11, v32, v52 row_newbcast:8 row_mask:0xf bank_mask:0xf
  v_dot2c_f32_bf16_dpp v12, v31, v53 row_newbcast:8 row_mask:0xf bank_mask:0xf
  v_dot2c_f32_bf16_dpp v13, v32, v53 row_newbcast:8 row_mask:0xf bank_mask:0xf
  v_dot2c_f32_bf16_dpp v14, v31, v54 row_newbcast:8 row_mask:0xf bank_mask:0xf
  v_dot2c_f32_bf16_dpp v15, v32, v54 row_newbcast:8 row_mask:0xf bank_mask:0xf
  v_dot2c_f32_bf16_dpp v16, v31, v55 row_newbcast:8 row_mask:0xf bank_mask:0xf
  v_dot2c_f32_bf16_dpp v17, v32, v55 row_newbcast:8 row_mask:0xf bank_mask:0xf
  s_waitcnt vmcnt(5)
  v_dot2c_f32_bf16_dpp v10, v31, v56 row_newbcast:4 row_mask:0xf bank_mask:0xf
  v_dot2c_f32_bf16_dpp v11, v32, v56 row_newbcast:4 row_mask:0xf bank_mask:0xf
  v_dot2c_f32_bf16_dpp v12, v31, v57 row_newbcast:4 row_mask:0xf bank_mask:0xf
  v_dot2c_f32_bf16_dpp v13, v32, v57 row_newbcast:4 row_mask:0xf bank_mask:0xf
  v_dot2c_f32_bf16_dpp v14, v31, v58 row_newbcast:4 row_mask:0xf bank_mask:0xf
  v_dot2c_f32_bf16_dpp v15, v32, v58 row_newbcast:4 row_mask:0xf bank_mask:0xf
  v_dot2c_f32_bf16_dpp v16, v31, v59 row_newbcast:4 row_mask:0xf bank_mask:0xf
  v_dot2c_f32_bf16_dpp v17, v32, v59 row_newbcast:4 row_mask:0xf bank_mask:0xf
  s_waitcnt vmcnt(4)
  v_dot2c_f32_bf16_dpp v10, v31, v60 row_newbcast:12 row_mask:0xf bank_mask:0xf
  v_dot2c_f32_bf16_dpp v11, v32, v60 row_newbcast:12 row_mask:0xf bank_mask:0xf
  v_dot2c_f32_bf16_dpp v12, v31, v61 row_newbcast:12 row_mask:0xf bank_mask:0xf
  v_dot2c_f32_bf16_dpp v13, v32, v61 row_newbcast:12 row_mask:0xf bank_mask:0xf
  v_dot2c_f32_bf16_dpp v14, v31, v62 row_newbcast:12 row_mask:0xf bank_mask:0xf
  v_dot2c_f32_bf16_dpp v15, v32, v62 row_newbcast:12 row_mask:0xf bank_mask:0xf
  v_dot2c_f32_bf16_dpp v16, v31, v63 row_newbcast:12 row_mask:0xf bank_mask:0xf
  v_dot2c_f32_bf16_dpp v17, v32, v63 row_newbcast:12 row_mask:0xf bank_mask:0xf
  s_waitcnt vmcnt(3)
  v_dot2c_f32_bf16_dpp v10, v31, v64 row_newbcast:2 row_mask:0xf bank_mask:0xf
  v_dot2c_f32_bf16_dpp v11, v32, v64 row_newbcast:2 row_mask:0xf bank_mask:0xf
  v_dot2c_f32_bf16_dpp v12, v31, v65 row_newbcast:2 row_mask:0xf bank_mask:0xf
  v_dot2c_f32_bf16_dpp v13, v32, v65 row_newbcast:2 row_mask:0xf bank_mask:0xf
  v_dot2c_f32_bf16_dpp v14, v31, v66 row_newbcast:2 row_mask:0xf bank_mask:0xf
  v_dot2c_f32_bf16_dpp v15, v32, v66 row_newbcast:2 row_mask:0xf bank_mask:0xf
  v_dot2c_f32_bf16_dpp v16, v31, v67 row_newbcast:2 row_mask:0xf bank_mask:0xf
  v_dot2c_f32_bf16_dpp v17, v32, v67 row_newbcast:2 row_mask:0xf bank_mask:0xf
  s_waitcnt vmcnt(2)
  v_dot2c_f32_bf16_dpp v10, v31, v68 row_newbcast:10 row_mask:0xf bank_mask:0xf
  v_dot2c_f32_bf16_dpp v11, v32, v68 row_newbcast:10 row_mask:0xf bank_mask:0xf
  v_dot2c_f32_bf16_dpp v12, v31, v69 row_newbcast:10 row_mask:0xf bank_mask:0xf
  v_dot2c_f32_bf16_dpp v13, v32, v69 row_newbcast:10 row_mask:0xf bank_mask:0xf
  v_dot2c_f32_bf16_dpp v14, v31, v70 row_newbcast:10 row_mask:0xf bank_mask:0xf
  v_dot2c_f32_bf16_dpp v15, v32, v70 row_newbcast:10 row_mask:0xf bank_mask:0xf
  v_dot2c_f32_bf16_dpp v16, v31, v71 row_newbcast:10 row_mask:0xf bank_mask:0xf
  v_dot2c_f32_bf16_dpp v17, v32, v71 row_newbcast:10 row_mask:0xf bank_mask:0xf
  s_waitcnt vmcnt(1)
  v_dot2c_f32_bf16_dpp v10, v31, v72 row_newbcast:6 row_mask:0xf bank_mask:0xf
  v_dot2c_f32_bf16_dpp v11, v32, v72 row_newbcast:6 row_mask:0xf bank_mask:0xf
  v_dot2c_f32_bf16_dpp v12, v31, v73 row_newbcast:6 row_mask:0xf bank_mask:0xf
  v_dot2c_f32_bf16_dpp v13, v32, v73 row_newbcast:6 row_mask:0xf bank_mask:0xf
  v_dot2c_f32_bf16_dpp v14, v31, v74 row_newbcast:6 row_mask:0xf bank_mask:0xf
  v_dot2c_f32_bf16_dpp v15, v32, v74 row_newbcast:6 row_mask:0xf bank_mask:0xf
  v_dot2c_f32_bf16_dpp v16, v31, v75 row_newbcast:6 row_mask:0xf bank_mask:0xf
  v_dot2c_f32_bf16_dpp v17, v32, v75 row_newbcast:6 row_mask:0xf bank_mask:0xf
  s_waitcnt vmcnt(0)
  v_dot2c_f32_bf16_dpp v10, v31, v76 row_newbcast:14 row_mask:0xf bank_mask:0xf
  v_dot2c_f32_bf16_dpp v11, v32, v76 row_newbcast:14 row_mask:0xf bank_mask:0xf
  v_dot2c_f32_bf16_dpp v12, v31, v77 row_newbcast:14 row_mask:0xf bank_mask:0xf
  v_dot2c_f32_bf16_dpp v13, v32, v77 row_newbcast:14 row_mask:0xf bank_mask:0xf
  v_dot2c_f32_bf16_dpp v14, v31, v78 row_newbcast:14 row_mask:0xf bank_mask:0xf
  v_dot2c_f32_bf16_dpp v15, v32, v78 row_newbcast:14 row_mask:0xf bank_mask:0xf
  v_dot2c_f32_bf16_dpp v16, v31, v79 row_newbcast:14 row_mask:0xf bank_mask:0xf
  v_dot2c_f32_bf16_dpp v17, v32, v79 row_newbcast:14 row_mask:0xf bank_mask:0xf
  s_nop 1
  s_branch L_drained
L_limV1:
  s_cmp_lg_u32 s35, 2
  s_cbranch_scc1 L_drainV1
  s_mov_b32 s78, 0
L_lw1:
  ds_read_b32 v43, v38 offset:16
  s_waitcnt lgkmcnt(0)
  v_readfirstlane_b32 s79, v43
  s_nop 0
  s_cmp_ge_u32 s79, 1
  s_nop 1
  s_cbranch_scc1 L_lwd1
  s_add_u32 s78, s78, 1
  s_cmp_gt_u32 s78, 0x400000
  s_cbranch_scc1 L_end
  s_sleep 2
  s_branch L_lw1
L_lwd1:
  ds_read_b64 v[46:47], v38 offset:24
  s_mov_b32 s33, 128
  s_mov_b32 s35, 3
  s_mov_b32 s37, 124
  s_waitcnt lgkmcnt(0)
  s_branch L_rV1
L_drainV1:
  v_add_u32 v43, s25, v45
  ds_read_u16 v28, v43
  v_sub_f32 v33, v29, v46
  v_mul_f32 v33, s77, v33
  v_exp_f32 v33, v33
  s_waitcnt lgkmcnt(0)
  v_lshlrev_b32 v28, 16, v28
  v_sub_f32 v28, v28, v46
  v_mul_f32 v28, s77, v28
  v_exp_f32 v28, v28
  v_mul_f32 v33, v33, v47
  v_mul_f32 v28, v28, v47
  v_cvt_pk_bf16_f32 v32, v28, v28
  v_mul_f32 v10, v10, v33
  v_mul_f32 v11, v11, v33
  v_mul_f32 v12, v12, v33
  v_mul_f32 v13, v13, v33
  v_mul_f32 v14, v14, v33
  v_mul_f32 v15, v15, v33
  v_mul_f32 v16, v16, v33
  v_mul_f32 v17, v17, v33
  v_and_b32 v31, 0xffff, v32
  v_and_b32 v32, 0xffff0000, v32
  s_waitcnt vmcnt(7)
  v_dot2c_f32_bf16_dpp v10, v31, v80 row_newbcast:0 row_mask:0xf bank_mask:0xf
  v_dot2c_f32_bf16_dpp v11, v32, v80 row_newbcast:0 row_mask:0xf bank_mask:0xf
  v_dot2c_f32_bf16_dpp v12, v31, v81 row_newbcast:0 row_mask:0xf bank_mask:0xf
  v_dot2c_f32_bf16_dpp v13, v32, v81 row_newbcast:0 row_mask:0xf bank_mask:0xf
  v_dot2c_f32_bf16_dpp v14, v31, v82 row_newbcast:0 row_mask:0xf bank_mask:0xf
  v_dot2c_f32_bf16_dpp v15, v32, v82 row_newbcast:0 row_mask:0xf bank_mask:0xf
  v_dot2c_f32_bf16_dpp v16, v31, v83 row_newbcast:0 row_mask:0xf bank_mask:0xf
  v_dot2c_f32_bf16_dpp v17, v32, v83 row_newbcast:0 row_mask:0xf bank_mask:0xf
  s_waitcnt vmcnt(6)
  v_dot2c_f32_bf16_dpp v10, v31, v84 row_newbcast:8 row_mask:0xf bank_mask:0xf
  v_dot2c_f32_bf16_dpp v11, v32, v84 row_newbcast:8 row_mask:0xf bank_mask:0xf
  v_dot2c_f32_bf16_dpp v12, v31, v85 row_newbcast:8 row_mask:0xf bank_mask:0xf
  v_dot2c_f32_bf16_dpp v13, v32, v85 row_newbcast:8 row_mask:0xf bank_mask:0xf
  v_dot2c_f32_bf16_dpp v14, v31, v86 row_newbcast:8 row_mask:0xf bank_mask:0xf
  v_dot2c_f32_bf16_dpp v15, v32, v86 row_newbcast:8 row_mask:0xf bank_mask:0xf
  v_dot2c_f32_bf16_dpp v16, v31, v87 row_newbcast:8 row_mask:0xf bank_mask:0xf
  v_dot2c_f32_bf16_dpp v17, v32, v87 row_newbcast:8 row_mask:0xf bank_mask:0xf
  s_waitcnt vmcnt(5)
  v_dot2c_f32_bf16_dpp v10, v31, v88 row_newbcast:4 row_mask:0xf bank_mask:0xf
  v_dot2c_f32_bf16_dpp v11, v32, v88 row_newbcast:4 row_mask:0xf bank_mask:0xf
  v_dot2c_f32_bf16_dpp v12, v31, v89 row_newbcast:4 row_mask:0xf bank_mask:0xf
  v_dot2c_f32_bf16_dpp v13, v32, v89 row_newbcast:4 row_mask:0xf bank_mask:0xf
  v_dot2c_f32_bf16_dpp v14, v31, v90 row_newbcast:4 row_mask:0xf bank_mask:0xf
  v_dot2c_f32_bf16_dpp v15, v32, v90 row_newbcast:4 row_mask:0xf bank_mask:0xf
  v_dot2c_f32_bf16_dpp v16, v31, v91 row_newbcast:4 row_mask:0xf bank_mask:0xf
  v_dot2c_f32_bf16_dpp v17, v32, v91 row_newbcast:4 row_mask:0xf bank_mask:0xf
  s_waitcnt vmcnt(4)
  v_dot2c_f32_bf16_dpp v10, v31, v92 row_newbcast:12 row_mask:0xf bank_mask:0xf
  v_dot2c_f32_bf16_dpp v11, v32, v92 row_newbcast:12 row_mask:0xf bank_mask:0xf
  v_dot2c_f32_bf16_dpp v12, v31, v93 row_newbcast:12 row_mask:0xf bank_mask:0xf
  v_dot2c_f32_bf16_dpp v13, v32, v93 row_newbcast:12 row_mask:0xf bank_mask:0xf
  v_dot2c_f32_bf16_dpp v14, v31, v94 row_newbcast:12 row_mask:0xf bank_mask:0xf
  v_dot2c_f32_bf16_dpp v15, v32, v94 row_newbcast:12 row_mask:0xf bank_mask:0xf
  v_dot2c_f32_bf16_dpp v16, v31, v95 row_newbcast:12 row_mask:0xf bank_mask:0xf
  v_dot2c_f32_bf16_dpp v17, v32, v95 row_newbcast:12 row_mask:0xf bank_mask:0xf
  s_waitcnt vmcnt(3)
  v_dot2c_f32_bf16_dpp v10, v31, v96 row_newbcast:2 row_mask:0xf bank_mask:0xf
  v_dot2c_f32_bf16_dpp v11, v32, v96 row_newbcast:2 row_mask:0xf bank_mask:0xf
  v_dot2c_f32_bf16_dpp v12, v31, v97 row_newbcast:2 row_mask:0xf bank_mask:0xf
  v_dot2c_f32_bf16_dpp v13, v32, v97 row_newbcast:2 row_mask:0xf bank_mask:0xf
  v_dot2c_f32_bf16_dpp v14, v31, v98 row_newbcast:2 row_mask:0xf bank_mask:0xf
  v_dot2c_f32_bf16_dpp v15, v32, v98 row_newbcast:2 row_mask:0xf bank_mask:0xf
  v_dot2c_f32_bf16_dpp v16, v31, v99 row_newbcast:2 row_mask:0xf bank_mask:0xf
  v_dot2c_f32_bf16_dpp v17, v32, v99 row_newbcast:2 row_mask:0xf bank_mask:0xf
  s_waitcnt vmcnt(2)
  v_dot2c_f32_bf16_dpp v10, v31, v100 row_newbcast:10 row_mask:0xf bank_mask:0xf
  v_dot2c_f32_bf16_dpp v11, v32, v100 row_newbcast:10 row_mask:0xf bank_mask:0xf
  v_dot2c_f32_bf16_dpp v12, v31, v101 row_newbcast:10 row_mask:0xf bank_mask:0xf
  v_dot2c_f32_bf16_dpp v13, v32, v101 row_newbcast:10 row_mask:0xf bank_mask:0xf
  v_dot2c_f32_bf16_dpp v14, v31, v102 row_newbcast:10 row_mask:0xf bank_mask:0xf
  v_dot2c_f32_bf16_dpp v15, v32, v102 row_newbcast:10 row_mask:0xf bank_mask:0xf
  v_dot2c_f32_bf16_dpp v16, v31, v103 row_newbcast:10 row_mask:0xf bank_mask:0xf
  v_dot2c_f32_bf16_dpp v17, v32, v103 row_newbcast:10 row_mask:0xf bank_mask:0xf
  s_waitcnt vmcnt(1)
  v_dot2c_f32_bf16_dpp v10, v31, v104 row_newbcast:6 row_mask:0xf bank_mask:0xf
  v_dot2c_f32_bf16_dpp v11, v32, v104 row_newbcast:6 row_mask:0xf bank_mask:0xf
  v_dot2c_f32_bf16_dpp v12, v31, v105 row_newbcast:6 row_mask:0xf bank_mask:0xf
  v_dot2c_f32_bf16_dpp v13, v32, v105 row_newbcast:6 row_mask:0xf bank_mask:0xf
  v_dot2c_f32_bf16_dpp v14, v31, v106 row_newbcast:6 row_mask:0xf bank_mask:0xf
  v_dot2c_f32_bf16_dpp v15, v32, v106 row_newbcast:6 row_mask:0xf bank_mask:0xf
  v_dot2c_f32_bf16_dpp v16, v31, v107 row_newbcast:6 row_mask:0xf bank_mask:0xf
  v_dot2c_f32_bf16_dpp v17, v32, v107 row_newbcast:6 row_mask:0xf bank_mask:0xf
  s_waitcnt vmcnt(0)
  v_dot2c_f32_bf16_dpp v10, v31, v108 row_newbcast:14 row_mask:0xf bank_mask:0xf
  v_dot2c_f32_bf16_dpp v11, v32, v108 row_newbcast:14 row_mask:0xf bank_mask:0xf
  v_dot2c_f32_bf16_dpp v12, v31, v109 row_newbcast:14 row_mask:0xf bank_mask:0xf
  v_dot2c_f32_bf16_dpp v13, v32, v109 row_newbcast:14 row_mask:0xf bank_mask:0xf
  v_dot2c_f32_bf16_dpp v14, v31, v110 row_newbcast:14 row_mask:0xf bank_mask:0xf
  v_dot2c_f32_bf16_dpp v15, v32, v110 row_newbcast:14 row_mask:0xf bank_mask:0xf
  v_dot2c_f32_bf16_dpp v16, v31, v111 row_newbcast:14 row_mask:0xf bank_mask:0xf
  v_dot2c_f32_bf16_dpp v17, v32, v111 row_newbcast:14 row_mask:0xf bank_mask:0xf
  s_nop 2
L_drained:
  v_permlane16_swap_b32 v10, v12
  v_permlane16_swap_b32 v11, v13
  v_permlane16_swap_b32 v14, v16
  v_permlane16_swap_b32 v15, v17
  v_add_f32 v10, v10, v12
  v_add_f32 v11, v11, v13
  v_add_f32 v14, v14, v16
  v_add_f32 v15, v15, v17
  s_nop 0
  v_permlane32_swap_b32 v10, v14
  v_permlane32_swap_b32 v11, v15
  v_add_f32 v10, v10, v14
  v_add_f32 v11, v11, v15
  ds_write_b64 v35, v[10:11]
  s_mov_b64 exec, 1
  ds_add_rtn_u32 v43, v38, v39 offset:8
  s_mov_b64 exec, -1
  ds_read_b64 v[12:13], v37 offset:0
  ds_read_b64 v[14:15], v37 offset:512
  ds_read_b64 v[16:17], v37 offset:1024
  ds_read_b64 v[18:19], v37 offset:1536
  s_waitcnt lgkmcnt(4)
  v_readfirstlane_b32 s79, v43
  s_nop 0
  s_cmp_lg_u32 s79, 3
  s_waitcnt lgkmcnt(0)
  s_nop 0
  s_cbranch_scc1 L_role
  v_add_f32 v12, v12, v14
  v_add_f32 v13, v13, v15
  v_add_f32 v16, v16, v18
  v_add_f32 v17, v17, v19
  v_add_f32 v12, v12, v16
  v_add_f32 v13, v13, v17
  v_cvt_pk_bf16_f32 v20, v12, v13
  v_min_u32 v20, -2, v20
  s_nop 1
  v_mov_b32_dpp v21, v20 quad_perm:[1,1,1,1] row_mask:0xf bank_mask:0xf
  v_mov_b32_dpp v22, v20 quad_perm:[2,2,2,2] row_mask:0xf bank_mask:0xf
  v_mov_b32_dpp v23, v20 quad_perm:[3,3,3,3] row_mask:0xf bank_mask:0xf
  s_mov_b32 exec_lo, 0x11111111
  s_mov_b32 exec_hi, 0x11111111
  buffer_store_dwordx4 v[20:23], v42, s[12:15], s28 offen sc1
  s_mov_b64 exec, -1
  s_branch L_role
L_helper:
  s_lshr_b32 s71, s65, 2
  s_and_b32 s79, s64, 6
  s_add_u32 s71, s71, s79
  s_and_b32 s71, s71, 7
  s_lshl_b32 s71, s71, 3
  s_add_u32 s71, s71, s64
  s_lshl_b32 s71, s71, 2
  s_and_b32 s79, s65, 3
  s_add_u32 s71, s71, s79
  s_sub_u32 s69, s3, 4
  s_waitcnt lgkmcnt(0)
  s_mov_b32 s12, s62
  s_mov_b32 s13, s63
  s_mov_b32 s14, 524288
  s_mov_b32 s15, 0x20000
  v_mov_b32 v9, 196608
  v_mov_b32 v38, 75904
  s_cmp_eq_u32 s3, 5
  s_cbranch_scc1 L_hbarA
  s_cmp_lt_u32 s3, 6
  s_cbranch_scc1 L_h45
  s_getpc_b64 s[16:17]
L_pcA:
  s_sub_u32 s16, s16, L_pcA-sequential_preLN__gqa_block_cached__geglu_ffn__decode_kernel
  s_subb_u32 s17, s17, 0
  s_lshl_b32 s79, s65, 1
  s_add_u32 s79, s79, s3
  s_sub_u32 s79, s79, 6
  s_and_b32 s79, s79, 31
  s_lshl_b32 s79, s79, 10
  v_add_u32 v220, s79, v3
  v_min_u32 v220, L_end-sequential_preLN__gqa_block_cached__geglu_ffn__decode_kernel-16, v220
  v_and_b32 v220, -16, v220
  v_mov_b32 v221, s17
  v_add_co_u32 v220, vcc, s16, v220
  s_nop 1
  v_addc_co_u32 v221, vcc, 0, v221, vcc
  global_load_dwordx4 v[216:219], v[220:221], off
  s_add_u32 s79, s79, 1024
  v_mov_b32 v10, 28
  v_mov_b32 v11, 0
  v_mov_b32 v12, 0
  v_mov_b32 v13, 0
  ds_write_b128 v38, v[10:13]
  ds_write_b64 v38, v[12:13] offset:16
  ds_write_b64 v38, v[12:13] offset:32
  ds_write_b64 v38, v[12:13] offset:40
  s_waitcnt lgkmcnt(0)
  s_branch L_hbarA
L_h45:
  buffer_load_dword v37, v9, s[12:15], 0 offen sc1
  s_setprio 2
  s_mov_b32 s16, s40
  s_mov_b32 s17, s41
  s_mov_b32 s18, 2560
  s_mov_b32 s19, 0x20000
  v_lshlrev_b32 v6, 2, v1
  v_lshl_add_u32 v7, v5, 2, v4
  v_lshlrev_b32 v7, 1, v7
  s_mul_i32 s72, s64, 160
  buffer_load_dword v10, v6, s[16:19], 0 offen offset:0
  buffer_load_dword v11, v6, s[16:19], 0 offen offset:256
  buffer_load_dword v12, v6, s[16:19], 0 offen offset:512
  buffer_load_dword v13, v6, s[16:19], 0 offen offset:768
  buffer_load_dword v14, v6, s[16:19], 0 offen offset:1024
  buffer_load_dword v15, v6, s[16:19], 0 offen offset:1280
  buffer_load_dword v16, v6, s[16:19], 0 offen offset:1536
  buffer_load_dword v17, v6, s[16:19], 0 offen offset:1792
  buffer_load_dword v18, v6, s[16:19], 0 offen offset:2048
  buffer_load_dword v19, v6, s[16:19], 0 offen offset:2304
  buffer_load_ushort v20, v7, s[16:19], s72 offen offset:0
  buffer_load_ushort v21, v7, s[16:19], s72 offen offset:128
  buffer_load_ushort v22, v7, s[16:19], s72 offen offset:1280
  buffer_load_ushort v23, v7, s[16:19], s72 offen offset:1408
  v_lshlrev_b32 v8, 13, v4
  v_lshl_add_u32 v8, v5, 4, v8
  s_mul_i32 s74, s64, 655360
  s_lshl_b32 s73, s65, 8
  s_add_u32 s74, s74, s73
  s_mov_b32 s73, 32768
  s_waitcnt lgkmcnt(0)
  s_mov_b32 s20, s46
  s_mov_b32 s21, s47
  s_mov_b32 s22, 5242880
  s_mov_b32 s23, 0x20000
  buffer_load_dwordx4 v[128:131], v8, s[20:23], s74 offen nt
  s_add_u32 s74, s74, s73
  buffer_load_dwordx4 v[132:135], v8, s[20:23], s74 offen nt
  s_add_u32 s74, s74, s73
  buffer_load_dwordx4 v[136:139], v8, s[20:23], s74 offen nt
  s_add_u32 s74, s74, s73
  buffer_load_dwordx4 v[140:143], v8, s[20:23], s74 offen nt
  s_add_u32 s74, s74, s73
  buffer_load_dwordx4 v[144:147], v8, s[20:23], s74 offen nt
  s_add_u32 s74, s74, s73
  buffer_load_dwordx4 v[148:151], v8, s[20:23], s74 offen nt
  s_add_u32 s74, s74, s73
  buffer_load_dwordx4 v[152:155], v8, s[20:23], s74 offen nt
  s_add_u32 s74, s74, s73
  buffer_load_dwordx4 v[156:159], v8, s[20:23], s74 offen nt
  s_add_u32 s74, s74, s73
  buffer_load_dwordx4 v[160:163], v8, s[20:23], s74 offen nt
  s_add_u32 s74, s74, s73
  buffer_load_dwordx4 v[164:167], v8, s[20:23], s74 offen nt
  s_add_u32 s74, s74, s73
  buffer_load_dwordx4 v[168:171], v8, s[20:23], s74 offen nt
  s_add_u32 s74, s74, s73
  buffer_load_dwordx4 v[172:175], v8, s[20:23], s74 offen nt
  s_add_u32 s74, s74, s73
  buffer_load_dwordx4 v[176:179], v8, s[20:23], s74 offen nt
  s_add_u32 s74, s74, s73
  buffer_load_dwordx4 v[180:183], v8, s[20:23], s74 offen nt
  s_add_u32 s74, s74, s73
  buffer_load_dwordx4 v[184:187], v8, s[20:23], s74 offen nt
  s_add_u32 s74, s74, s73
  buffer_load_dwordx4 v[188:191], v8, s[20:23], s74 offen nt
  s_add_u32 s74, s74, s73
  buffer_load_dwordx4 v[192:195], v8, s[20:23], s74 offen nt
  s_add_u32 s74, s74, s73
  buffer_load_dwordx4 v[196:199], v8, s[20:23], s74 offen nt
  s_add_u32 s74, s74, s73
  buffer_load_dwordx4 v[200:203], v8, s[20:23], s74 offen nt
  s_add_u32 s74, s74, s73
  buffer_load_dwordx4 v[204:207], v8, s[20:23], s74 offen nt
  s_lshl_b32 s79, s66, 1
  s_add_u32 s79, s79, s67
  s_lshl_b32 s79, s79, 2
  s_add_u32 s79, s79, s68
  s_mul_i32 s70, s79, 256
  v_add_u32 v72, s70, v3
  v_mov_b32 v73, 0x7ff00000
  s_mov_b32 vcc_lo, 0xffff
  s_mov_b32 vcc_hi, 0
  v_cndmask_b32 v72, v73, v72, vcc
  s_mul_i32 s72, s71, 6554
  s_lshr_b32 s72, s72, 16
  s_mul_i32 s73, s72, 10
  s_sub_u32 s73, s71, s73
  s_lshl_b32 s73, s73, 4
  s_add_u32 s72, s72, s73
  s_mul_i32 s72, s72, 128
  s_add_u32 s72, s72, 131072
  s_sub_u32 s79, s71, 80
  s_lshr_b32 s73, s79, 2
  s_lshl_b32 s73, s73, 1
  s_and_b32 s74, s79, 1
  s_add_u32 s73, s73, s74
  s_bfe_u32 s74, s79, 0x10001
  s_mul_i32 s74, s74, 54
  s_add_u32 s73, s73, s74
  s_mul_i32 s73, s73, 128
  s_add_u32 s73, s73, 163840
  s_cmp_lt_u32 s71, 80
  s_cselect_b32 s72, s72, s73
  s_cselect_b32 s74, 48, 40
  s_cmp_lt_u32 s71, 188
  s_cselect_b32 s74, s74, 0
  v_bfe_u32 v74, v1, 3, 1
  v_mul_u32_u24 v74, 1024, v74
  v_and_b32 v75, 7, v1
  v_lshl_add_u32 v74, v75, 4, v74
  v_add_u32 v74, s72, v74
  v_cmp_gt_u32 vcc, s74, v1
  s_nop 1
  v_cndmask_b32 v74, v73, v74, vcc
  v_cmp_lt_u32 vcc, 31, v1
  s_nop 1
  v_cndmask_b32 v72, v72, v74, vcc
  s_lshl_b32 s79, s39, 6
  s_lshl_b32 s78, s68, 4
  s_add_u32 s79, s79, s78
  s_add_u32 s79, s79, 204800
  v_mov_b32 v74, s79
  v_subrev_u32 v75, 17, v1
  v_lshl_add_u32 v74, v75, 12, v74
  v_cmp_gt_u32 vcc, 3, v75
  s_nop 1
  v_cndmask_b32 v72, v72, v74, vcc
  v_mov_b32 v76, -1
  v_mov_b32 v77, -1
  v_mov_b32 v78, -1
  v_mov_b32 v79, -1
  buffer_store_dwordx4 v[76:79], v72, s[12:15], 0 offen sc1
  s_lshl_b32 s79, s2, 4
  s_add_u32 s79, s79, 200704
  v_mov_b32 v75, s79
  v_lshrrev_b32 v28, 3, v5
  v_mul_u32_u24 v28, 0x202, v28
  v_add_u32 v28, 0x100, v28
  v_or_b32 v29, 0x0c0c0000, v28
  v_lshlrev_b32 v28, 16, v28
  v_or_b32 v28, 0x0c0c, v28
  v_and_b32 v30, 1, v5
  v_cmp_eq_u32 vcc, 1, v30
  s_nop 1
  v_cndmask_b32 v28, v29, v28, vcc
  v_bfe_u32 v30, v5, 1, 2
  v_mov_b32 v29, 0x0c0c0c0c
  v_cmp_eq_u32 vcc, 0, v30
  s_nop 1
  v_cndmask_b32 v24, v29, v28, vcc
  v_cmp_eq_u32 vcc, 1, v30
  s_nop 1
  v_cndmask_b32 v25, v29, v28, vcc
  v_cmp_eq_u32 vcc, 2, v30
  s_nop 1
  v_cndmask_b32 v26, v29, v28, vcc
  v_cmp_eq_u32 vcc, 3, v30
  s_nop 1
  v_cndmask_b32 v27, v29, v28, vcc
  v_lshrrev_b32 v7, 1, v4
  v_lshlrev_b32 v7, 12, v7
  v_lshl_add_u32 v7, v5, 5, v7
  v_and_b32 v30, 1, v4
  v_lshl_add_u32 v7, v30, 4, v7
  s_lshl_b32 s70, s65, 4
  s_add_u32 s70, s70, s64
  s_lshl_b32 s70, s70, 9
  s_add_u32 s70, s70, 262144
  s_waitcnt vmcnt(21)
  v_add_u32 v6, 81408, v6
  ds_write_b32 v6, v10 offset:0
  ds_write_b32 v6, v11 offset:256
  ds_write_b32 v6, v12 offset:512
  ds_write_b32 v6, v13 offset:768
  ds_write_b32 v6, v14 offset:1024
  ds_write_b32 v6, v15 offset:1280
  ds_write_b32 v6, v16 offset:1536
  ds_write_b32 v6, v17 offset:1792
  ds_write_b32 v6, v18 offset:2048
  ds_write_b32 v6, v19 offset:2304
  v_lshlrev_b32 v40, 16, v10
  v_and_b32 v41, 0xffff0000, v10
  v_lshlrev_b32 v42, 16, v11
  v_and_b32 v43, 0xffff0000, v11
  v_lshlrev_b32 v44, 16, v12
  v_and_b32 v45, 0xffff0000, v12
  v_lshlrev_b32 v46, 16, v13
  v_and_b32 v47, 0xffff0000, v13
  v_lshlrev_b32 v48, 16, v14
  v_and_b32 v49, 0xffff0000, v14
  v_lshlrev_b32 v50, 16, v15
  v_and_b32 v51, 0xffff0000, v15
  v_lshlrev_b32 v52, 16, v16
  v_and_b32 v53, 0xffff0000, v16
  v_lshlrev_b32 v54, 16, v17
  v_and_b32 v55, 0xffff0000, v17
  v_lshlrev_b32 v56, 16, v18
  v_and_b32 v57, 0xffff0000, v18
  v_lshlrev_b32 v58, 16, v19
  v_and_b32 v59, 0xffff0000, v19
  s_waitcnt lgkmcnt(0)
  v_add_f32 v32, v40, v41
  v_add_f32 v33, v50, v51
  v_add_f32 v32, v32, v42
  v_add_f32 v33, v33, v52
  v_add_f32 v32, v32, v43
  v_add_f32 v33, v33, v53
  v_add_f32 v32, v32, v44
  v_add_f32 v33, v33, v54
  v_add_f32 v32, v32, v45
  v_add_f32 v33, v33, v55
  v_add_f32 v32, v32, v46
  v_add_f32 v33, v33, v56
  v_add_f32 v32, v32, v47
  v_add_f32 v33, v33, v57
  v_add_f32 v32, v32, v48
  v_add_f32 v33, v33, v58
  v_add_f32 v32, v32, v49
  v_add_f32 v33, v33, v59
  s_nop 0
  v_add_f32_dpp v32, v32, v32 row_ror:8 row_mask:0xf bank_mask:0xf
  v_add_f32_dpp v33, v33, v33 row_ror:8 row_mask:0xf bank_mask:0xf
  s_nop 0
  v_add_f32_dpp v32, v32, v32 row_ror:4 row_mask:0xf bank_mask:0xf
  v_add_f32_dpp v33, v33, v33 row_ror:4 row_mask:0xf bank_mask:0xf
  s_nop 0
  v_add_f32_dpp v32, v32, v32 row_ror:2 row_mask:0xf bank_mask:0xf
  v_add_f32_dpp v33, v33, v33 row_ror:2 row_mask:0xf bank_mask:0xf
  s_nop 0
  v_add_f32_dpp v32, v32, v32 row_ror:1 row_mask:0xf bank_mask:0xf
  v_add_f32_dpp v33, v33, v33 row_ror:1 row_mask:0xf bank_mask:0xf
  v_mov_b32 v10, v32
  v_mov_b32 v11, v33
  s_nop 0
  v_permlane16_swap_b32 v10, v32
  v_permlane16_swap_b32 v11, v33
  v_add_f32 v32, v32, v10
  v_add_f32 v33, v33, v11
  v_mov_b32 v10, v32
  v_mov_b32 v11, v33
  s_nop 0
  v_permlane32_swap_b32 v10, v32
  v_permlane32_swap_b32 v11, v33
  v_add_f32 v32, v32, v10
  v_add_f32 v33, v33, v11
  v_mul_f32 v32, 986500301, v32
  v_mul_f32 v33, 986500301, v33
  v_sub_f32 v40, v40, v32
  v_sub_f32 v50, v50, v33
  v_sub_f32 v41, v41, v32
  v_sub_f32 v51, v51, v33
  v_sub_f32 v42, v42, v32
  v_sub_f32 v52, v52, v33
  v_sub_f32 v43, v43, v32
  v_sub_f32 v53, v53, v33
  v_sub_f32 v44, v44, v32
  v_sub_f32 v54, v54, v33
  v_sub_f32 v45, v45, v32
  v_sub_f32 v55, v55, v33
  v_sub_f32 v46, v46, v32
  v_sub_f32 v56, v56, v33
  v_sub_f32 v47, v47, v32
  v_sub_f32 v57, v57, v33
  v_sub_f32 v48, v48, v32
  v_sub_f32 v58, v58, v33
  v_sub_f32 v49, v49, v32
  v_sub_f32 v59, v59, v33
  v_mul_f32 v34, v40, v40
  v_mul_f32 v35, v50, v50
  v_fmac_f32 v34, v41, v41
  v_fmac_f32 v35, v51, v51
  v_fmac_f32 v34, v42, v42
  v_fmac_f32 v35, v52, v52
  v_fmac_f32 v34, v43, v43
  v_fmac_f32 v35, v53, v53
  v_fmac_f32 v34, v44, v44
  v_fmac_f32 v35, v54, v54
  v_fmac_f32 v34, v45, v45
  v_fmac_f32 v35, v55, v55
  v_fmac_f32 v34, v46, v46
  v_fmac_f32 v35, v56, v56
  v_fmac_f32 v34, v47, v47
  v_fmac_f32 v35, v57, v57
  v_fmac_f32 v34, v48, v48
  v_fmac_f32 v35, v58, v58
  v_fmac_f32 v34, v49, v49
  v_fmac_f32 v35, v59, v59
  s_nop 0
  v_add_f32_dpp v34, v34, v34 row_ror:8 row_mask:0xf bank_mask:0xf
  v_add_f32_dpp v35, v35, v35 row_ror:8 row_mask:0xf bank_mask:0xf
  s_nop 0
  v_add_f32_dpp v34, v34, v34 row_ror:4 row_mask:0xf bank_mask:0xf
  v_add_f32_dpp v35, v35, v35 row_ror:4 row_mask:0xf bank_mask:0xf
  s_nop 0
  v_add_f32_dpp v34, v34, v34 row_ror:2 row_mask:0xf bank_mask:0xf
  v_add_f32_dpp v35, v35, v35 row_ror:2 row_mask:0xf bank_mask:0xf
  s_nop 0
  v_add_f32_dpp v34, v34, v34 row_ror:1 row_mask:0xf bank_mask:0xf
  v_add_f32_dpp v35, v35, v35 row_ror:1 row_mask:0xf bank_mask:0xf
  v_mov_b32 v10, v34
  v_mov_b32 v11, v35
  s_nop 0
  v_permlane16_swap_b32 v10, v34
  v_permlane16_swap_b32 v11, v35
  v_add_f32 v34, v34, v10
  v_add_f32 v35, v35, v11
  v_mov_b32 v10, v34
  v_mov_b32 v11, v35
  s_nop 0
  v_permlane32_swap_b32 v10, v34
  v_permlane32_swap_b32 v11, v35
  v_add_f32 v34, v34, v10
  v_add_f32 v35, v35, v11
  v_mul_f32 v34, 986500301, v34
  v_mul_f32 v35, 986500301, v35
  v_cvt_pk_bf16_f32 v12, v34, v35
  v_lshlrev_b32 v34, 16, v12
  v_and_b32 v35, 0xffff0000, v12
  v_cvt_pk_bf16_f32 v12, v32, v33
  v_lshlrev_b32 v32, 16, v12
  v_and_b32 v33, 0xffff0000, v12
  v_add_f32 v34, 925353388, v34
  v_add_f32 v35, 925353388, v35
  v_cvt_pk_bf16_f32 v12, v34, v35
  v_lshlrev_b32 v34, 16, v12
  v_and_b32 v35, 0xffff0000, v12
  v_sqrt_f32 v34, v34
  v_sqrt_f32 v35, v35
  v_lshlrev_b32 v20, 16, v20
  v_lshlrev_b32 v21, 16, v21
  v_lshlrev_b32 v22, 16, v22
  v_lshlrev_b32 v23, 16, v23
  v_cvt_pk_bf16_f32 v12, v34, v35
  v_lshlrev_b32 v34, 16, v12
  v_and_b32 v35, 0xffff0000, v12
  v_rcp_f32 v34, v34
  v_rcp_f32 v35, v35
  v_sub_f32 v20, v20, v32
  v_sub_f32 v21, v21, v32
  v_sub_f32 v22, v22, v33
  v_sub_f32 v23, v23, v33
  v_cvt_pk_bf16_f32 v12, v20, v21
  v_lshlrev_b32 v20, 16, v12
  v_and_b32 v21, 0xffff0000, v12
  v_cvt_pk_bf16_f32 v12, v22, v23
  v_lshlrev_b32 v22, 16, v12
  v_and_b32 v23, 0xffff0000, v12
  v_mul_f32 v20, v20, v34
  v_mul_f32 v21, v21, v34
  v_mul_f32 v22, v22, v35
  v_mul_f32 v23, v23, v35
  v_cvt_pk_bf16_f32 v30, v20, v22
  v_cvt_pk_bf16_f32 v31, v21, v23
  v_add_u32 v65, 2654435761, v37
  v_mov_b32_dpp v12, v30 row_newbcast:0 row_mask:0xf bank_mask:0xf
  v_perm_b32 v40, v12, v12, v24
  v_perm_b32 v41, v12, v12, v25
  v_perm_b32 v42, v12, v12, v26
  v_perm_b32 v43, v12, v12, v27
  s_waitcnt vmcnt(20)
  s_nop 0
  v_mfma_f32_16x16x32_bf16 v[60:63], v[40:43], v[128:131], 0
  v_mov_b32_dpp v13, v30 row_newbcast:1 row_mask:0xf bank_mask:0xf
  v_perm_b32 v44, v13, v13, v24
  v_perm_b32 v45, v13, v13, v25
  v_perm_b32 v46, v13, v13, v26
  v_perm_b32 v47, v13, v13, v27
  s_waitcnt vmcnt(19)
  s_nop 0
  v_mfma_f32_16x16x32_bf16 v[60:63], v[44:47], v[132:135], v[60:63]
  v_mov_b32_dpp v12, v30 row_newbcast:2 row_mask:0xf bank_mask:0xf
  v_perm_b32 v48, v12, v12, v24
  v_perm_b32 v49, v12, v12, v25
  v_perm_b32 v50, v12, v12, v26
  v_perm_b32 v51, v12, v12, v27
  s_waitcnt vmcnt(18)
  s_nop 0
  v_mfma_f32_16x16x32_bf16 v[60:63], v[48:51], v[136:139], v[60:63]
  v_mov_b32_dpp v13, v30 row_newbcast:3 row_mask:0xf bank_mask:0xf
  v_perm_b32 v52, v13, v13, v24
  v_perm_b32 v53, v13, v13, v25
  v_perm_b32 v54, v13, v13, v26
  v_perm_b32 v55, v13, v13, v27
  s_waitcnt vmcnt(17)
  s_nop 0
  v_mfma_f32_16x16x32_bf16 v[60:63], v[52:55], v[140:143], v[60:63]
  v_mov_b32_dpp v12, v30 row_newbcast:4 row_mask:0xf bank_mask:0xf
  v_perm_b32 v40, v12, v12, v24
  v_perm_b32 v41, v12, v12, v25
  v_perm_b32 v42, v12, v12, v26
  v_perm_b32 v43, v12, v12, v27
  s_waitcnt vmcnt(16)
  s_nop 0
  v_mfma_f32_16x16x32_bf16 v[60:63], v[40:43], v[144:147], v[60:63]
  v_mov_b32_dpp v13, v30 row_newbcast:5 row_mask:0xf bank_mask:0xf
  v_perm_b32 v44, v13, v13, v24
  v_perm_b32 v45, v13, v13, v25
  v_perm_b32 v46, v13, v13, v26
  v_perm_b32 v47, v13, v13, v27
  s_waitcnt vmcnt(15)
  s_nop 0
  v_mfma_f32_16x16x32_bf16 v[60:63], v[44:47], v[148:151], v[60:63]
  v_mov_b32_dpp v12, v30 row_newbcast:6 row_mask:0xf bank_mask:0xf
  v_perm_b32 v48, v12, v12, v24
  v_perm_b32 v49, v12, v12, v25
  v_perm_b32 v50, v12, v12, v26
  v_perm_b32 v51, v12, v12, v27
  s_waitcnt vmcnt(14)
  s_nop 0
  v_mfma_f32_16x16x32_bf16 v[60:63], v[48:51], v[152:155], v[60:63]
  v_mov_b32_dpp v13, v30 row_newbcast:7 row_mask:0xf bank_mask:0xf
  v_perm_b32 v52, v13, v13, v24
  v_perm_b32 v53, v13, v13, v25
  v_perm_b32 v54, v13, v13, v26
  v_perm_b32 v55, v13, v13, v27
  s_waitcnt vmcnt(13)
  s_nop 0
  v_mfma_f32_16x16x32_bf16 v[60:63], v[52:55], v[156:159], v[60:63]
  v_mov_b32_dpp v12, v30 row_newbcast:8 row_mask:0xf bank_mask:0xf
  v_perm_b32 v40, v12, v12, v24
  v_perm_b32 v41, v12, v12, v25
  v_perm_b32 v42, v12, v12, v26
  v_perm_b32 v43, v12, v12, v27
  s_waitcnt vmcnt(12)
  s_nop 0
  v_mfma_f32_16x16x32_bf16 v[60:63], v[40:43], v[160:163], v[60:63]
  v_mov_b32_dpp v13, v30 row_newbcast:9 row_mask:0xf bank_mask:0xf
  v_perm_b32 v44, v13, v13, v24
  v_perm_b32 v45, v13, v13, v25
  v_perm_b32 v46, v13, v13, v26
  v_perm_b32 v47, v13, v13, v27
  s_waitcnt vmcnt(11)
  s_nop 0
  v_mfma_f32_16x16x32_bf16 v[60:63], v[44:47], v[164:167], v[60:63]
  v_mov_b32_dpp v12, v30 row_newbcast:10 row_mask:0xf bank_mask:0xf
  v_perm_b32 v48, v12, v12, v24
  v_perm_b32 v49, v12, v12, v25
  v_perm_b32 v50, v12, v12, v26
  v_perm_b32 v51, v12, v12, v27
  s_waitcnt vmcnt(10)
  s_nop 0
  v_mfma_f32_16x16x32_bf16 v[60:63], v[48:51], v[168:171], v[60:63]
  v_mov_b32_dpp v13, v30 row_newbcast:11 row_mask:0xf bank_mask:0xf
  v_perm_b32 v52, v13, v13, v24
  v_perm_b32 v53, v13, v13, v25
  v_perm_b32 v54, v13, v13, v26
  v_perm_b32 v55, v13, v13, v27
  s_waitcnt vmcnt(9)
  s_nop 0
  v_mfma_f32_16x16x32_bf16 v[60:63], v[52:55], v[172:175], v[60:63]
  v_mov_b32_dpp v12, v30 row_newbcast:12 row_mask:0xf bank_mask:0xf
  v_perm_b32 v40, v12, v12, v24
  v_perm_b32 v41, v12, v12, v25
  v_perm_b32 v42, v12, v12, v26
  v_perm_b32 v43, v12, v12, v27
  s_waitcnt vmcnt(8)
  s_nop 0
  v_mfma_f32_16x16x32_bf16 v[60:63], v[40:43], v[176:179], v[60:63]
  v_mov_b32_dpp v13, v30 row_newbcast:13 row_mask:0xf bank_mask:0xf
  v_perm_b32 v44, v13, v13, v24
  v_perm_b32 v45, v13, v13, v25
  v_perm_b32 v46, v13, v13, v26
  v_perm_b32 v47, v13, v13, v27
  s_waitcnt vmcnt(7)
  s_nop 0
  v_mfma_f32_16x16x32_bf16 v[60:63], v[44:47], v[180:183], v[60:63]
  v_mov_b32_dpp v12, v30 row_newbcast:14 row_mask:0xf bank_mask:0xf
  v_perm_b32 v48, v12, v12, v24
  v_perm_b32 v49, v12, v12, v25
  v_perm_b32 v50, v12, v12, v26
  v_perm_b32 v51, v12, v12, v27
  s_waitcnt vmcnt(6)
  s_nop 0
  v_mfma_f32_16x16x32_bf16 v[60:63], v[48:51], v[184:187], v[60:63]
  v_mov_b32_dpp v13, v30 row_newbcast:15 row_mask:0xf bank_mask:0xf
  v_perm_b32 v52, v13, v13, v24
  v_perm_b32 v53, v13, v13, v25
  v_perm_b32 v54, v13, v13, v26
  v_perm_b32 v55, v13, v13, v27
  s_waitcnt vmcnt(5)
  s_nop 0
  v_mfma_f32_16x16x32_bf16 v[60:63], v[52:55], v[188:191], v[60:63]
  v_mov_b32_dpp v12, v31 row_newbcast:0 row_mask:0xf bank_mask:0xf
  v_perm_b32 v40, v12, v12, v24
  v_perm_b32 v41, v12, v12, v25
  v_perm_b32 v42, v12, v12, v26
  v_perm_b32 v43, v12, v12, v27
  s_waitcnt vmcnt(4)
  s_nop 0
  v_mfma_f32_16x16x32_bf16 v[60:63], v[40:43], v[192:195], v[60:63]
  v_mov_b32_dpp v13, v31 row_newbcast:1 row_mask:0xf bank_mask:0xf
  v_perm_b32 v44, v13, v13, v24
  v_perm_b32 v45, v13, v13, v25
  v_perm_b32 v46, v13, v13, v26
  v_perm_b32 v47, v13, v13, v27
  s_waitcnt vmcnt(3)
  s_nop 0
  v_mfma_f32_16x16x32_bf16 v[60:63], v[44:47], v[196:199], v[60:63]
  v_mov_b32_dpp v12, v31 row_newbcast:2 row_mask:0xf bank_mask:0xf
  v_perm_b32 v48, v12, v12, v24
  v_perm_b32 v49, v12, v12, v25
  v_perm_b32 v50, v12, v12, v26
  v_perm_b32 v51, v12, v12, v27
  s_waitcnt vmcnt(2)
  s_nop 0
  v_mfma_f32_16x16x32_bf16 v[60:63], v[48:51], v[200:203], v[60:63]
  v_mov_b32_dpp v13, v31 row_newbcast:3 row_mask:0xf bank_mask:0xf
  v_perm_b32 v52, v13, v13, v24
  v_perm_b32 v53, v13, v13, v25
  v_perm_b32 v54, v13, v13, v26
  v_perm_b32 v55, v13, v13, v27
  s_waitcnt vmcnt(1)
  s_nop 0
  v_mfma_f32_16x16x32_bf16 v[60:63], v[52:55], v[204:207], v[60:63]
  s_nop 7
  v_bfi_b32 v60, 15, v65, v60
  v_bfi_b32 v61, 15, v65, v61
  v_bfi_b32 v62, 15, v65, v62
  v_bfi_b32 v63, 15, v65, v63
  buffer_store_dwordx4 v[60:63], v7, s[12:15], s70 offen sc1
  s_setprio 0
  s_waitcnt vmcnt(0)
  s_mov_b64 exec, 1
  buffer_store_dword v65, v75, s[12:15], 0 offen sc1
  s_mov_b64 exec, -1
L_h5:
  s_lshl_b32 s70, s66, 1
  s_add_u32 s70, s70, s67
  s_lshl_b32 s70, s70, 12
  s_add_u32 s70, s70, 262144
  v_and_b32 v6, 31, v1
  v_lshlrev_b32 v6, 3, v6
  v_add_u32 v6, 65536, v6
  s_mov_b32 s78, 0
  v_add_u32 v37, 2654435761, v37
  s_nop 1
L_qpoll:
  buffer_load_dwordx4 v[64:67], v3, s[12:15], s70 offen offset:0 sc1
  buffer_load_dwordx4 v[68:71], v3, s[12:15], s70 offen offset:1024 sc1
  buffer_load_dwordx4 v[72:75], v3, s[12:15], s70 offen offset:2048 sc1
  buffer_load_dwordx4 v[76:79], v3, s[12:15], s70 offen offset:3072 sc1
  s_waitcnt vmcnt(0)
  v_xor_b32 v80, v64, v37
  v_xor_b32 v81, v65, v37
  v_xor_b32 v82, v66, v37
  v_xor_b32 v83, v67, v37
  v_xor_b32 v84, v68, v37
  v_xor_b32 v85, v69, v37
  v_xor_b32 v86, v70, v37
  v_xor_b32 v87, v71, v37
  v_xor_b32 v88, v72, v37
  v_xor_b32 v89, v73, v37
  v_xor_b32 v90, v74, v37
  v_xor_b32 v91, v75, v37
  v_xor_b32 v92, v76, v37
  v_xor_b32 v93, v77, v37
  v_xor_b32 v94, v78, v37
  v_xor_b32 v95, v79, v37
  v_or_b32 v8, v80, v81
  v_or3_b32 v8, v8, v82, v83
  v_or3_b32 v8, v8, v84, v85
  v_or3_b32 v8, v8, v86, v87
  v_or3_b32 v8, v8, v88, v89
  v_or3_b32 v8, v8, v90, v91
  v_or3_b32 v8, v8, v92, v93
  v_or3_b32 v8, v8, v94, v95
  v_and_b32 v8, 15, v8
  v_cmp_ne_u32 vcc, 0, v8
  s_nop 3
  s_cbranch_vccz L_qdone
  s_add_u32 s78, s78, 1
  s_cmp_gt_u32 s78, 0x100000
  s_cbranch_scc1 L_end
  s_sleep 16
  s_branch L_qpoll
L_qdone:
  v_bfi_b32 v64, 15, 8, v64
  v_bfi_b32 v65, 15, 8, v65
  v_bfi_b32 v66, 15, 8, v66
  v_bfi_b32 v67, 15, 8, v67
  v_bfi_b32 v68, 15, 8, v68
  v_bfi_b32 v69, 15, 8, v69
  v_bfi_b32 v70, 15, 8, v70
  v_bfi_b32 v71, 15, 8, v71
  v_bfi_b32 v72, 15, 8, v72
  v_bfi_b32 v73, 15, 8, v73
  v_bfi_b32 v74, 15, 8, v74
  v_bfi_b32 v75, 15, 8, v75
  v_bfi_b32 v76, 15, 8, v76
  v_bfi_b32 v77, 15, 8, v77
  v_bfi_b32 v78, 15, 8, v78
  v_bfi_b32 v79, 15, 8, v79
  v_add_f32 v64, v64, v68
  v_add_f32 v72, v72, v76
  v_add_f32 v65, v65, v69
  v_add_f32 v73, v73, v77
  v_add_f32 v66, v66, v70
  v_add_f32 v74, v74, v78
  v_add_f32 v67, v67, v71
  v_add_f32 v75, v75, v79
  v_add_f32 v64, v64, v72
  v_mov_b32 v68, v64
  v_add_f32 v65, v65, v73
  v_mov_b32 v69, v65
  v_add_f32 v66, v66, v74
  v_mov_b32 v70, v66
  v_add_f32 v67, v67, v75
  v_mov_b32 v71, v67
  v_permlane32_swap_b32 v64, v68
  v_permlane32_swap_b32 v65, v69
  v_permlane32_swap_b32 v66, v70
  v_permlane32_swap_b32 v67, v71
  v_add_f32 v64, v64, v68
  v_add_f32 v65, v65, v69
  v_add_f32 v66, v66, v70
  v_add_f32 v67, v67, v71
  v_cvt_pk_bf16_f32 v10, v64, v65
  v_cvt_pk_bf16_f32 v11, v66, v67
  ds_write_b64 v6, v[10:11]
  s_waitcnt lgkmcnt(0)
L_hbarA:
  s_barrier
  s_cmp_lg_u32 s3, 5
  s_cbranch_scc1 L_h_go
  s_mov_b32 s78, 0
L_lw2:
  ds_read_b32 v7, v38 offset:0
  s_waitcnt lgkmcnt(0)
  v_readfirstlane_b32 s79, v7
  s_nop 0
  s_cmp_ge_u32 s79, 36
  s_nop 1
  s_cbranch_scc1 L_lwd2
  s_add_u32 s78, s78, 1
  s_cmp_gt_u32 s78, 0x400000
  s_cbranch_scc1 L_end
  s_sleep 32
  s_branch L_lw2
L_lwd2:
  buffer_load_dword v37, v9, s[12:15], 0 offen sc1
  s_waitcnt vmcnt(0)
  v_add_u32 v37, 2654435761, v37
  s_mov_b32 s72, 200704
  s_mov_b32 s78, 0
  v_mov_b32 v39, 1
  s_nop 1
L_chk:
  buffer_load_dword v10, v3, s[12:15], s72 offen offset:0 sc1
  buffer_load_dword v11, v3, s[12:15], s72 offen offset:1024 sc1
  buffer_load_dword v12, v3, s[12:15], s72 offen offset:2048 sc1
  buffer_load_dword v13, v3, s[12:15], s72 offen offset:3072 sc1
  s_waitcnt vmcnt(0)
  v_xor_b32 v10, v10, v37
  v_xor_b32 v11, v11, v37
  v_xor_b32 v12, v12, v37
  v_xor_b32 v13, v13, v37
  v_or3_b32 v10, v10, v11, v12
  v_or_b32 v10, v10, v13
  v_cmp_ne_u32 vcc, 0, v10
  s_nop 3
  s_cbranch_vccz L_chkd
  s_add_u32 s78, s78, 1
  s_cmp_gt_u32 s78, 0x100000
  s_cbranch_scc1 L_end
  s_sleep 32
  s_branch L_chk
L_chkd:
  ds_write_b32 v38, v39 offset:4
L_h_go:
L_role:
  s_lshr_b32 s71, s65, 2
  s_and_b32 s79, s64, 6
  s_add_u32 s71, s71, s79
  s_and_b32 s71, s71, 7
  s_lshl_b32 s71, s71, 3
  s_add_u32 s71, s71, s64
  s_lshl_b32 s71, s71, 2
  s_and_b32 s79, s65, 3
  s_add_u32 s71, s71, s79
  v_mov_b32 v38, 75904
  s_cmp_lt_u32 s71, 228
  s_cbranch_scc1 L_hasrole
  s_cmp_lg_u32 s3, 6
  s_cbranch_scc1 L_fin
  s_call_b64 s[20:21], L_balance
  s_branch L_fin
L_balance:
  s_lshl_b32 s18, s39, 6
  s_add_u32 s18, s18, 204800
  v_add_u32 v200, s18, v3
  v_mov_b32 v201, 0x7ff00000
  v_cmp_gt_u32 vcc, 4, v1
  s_nop 1
  v_cndmask_b32 v200, v201, v200, vcc
  v_cmp_eq_u32 vcc, s68, v1
  s_nop 1
  v_cndmask_b32 v201, v201, v200, vcc
  s_cmp_lt_u32 s71, 228
  s_cselect_b32 s18, 0, 0
  s_cmp_lt_u32 s71, 188
  s_cselect_b32 s18, 0, s18
  s_cmp_lt_u32 s71, 80
  s_cselect_b32 s18, 110, s18
  s_mov_b32 s78, 0
L_lw3:
  ds_read_b32 v61, v38 offset:0
  s_waitcnt lgkmcnt(0)
  v_readfirstlane_b32 s79, v61
  s_nop 0
  s_cmp_ge_u32 s79, 48
  s_nop 1
  s_cbranch_scc1 L_lwd3
  s_add_u32 s78, s78, 1
  s_cmp_gt_u32 s78, 0x400000
  s_cbranch_scc1 L_end
  s_sleep 2
  s_branch L_lw3
L_lwd3:
  s_memrealtime s[22:23]
  v_mov_b32 v214, 0
  s_mov_b32 s78, 4096
  s_waitcnt lgkmcnt(0)
  s_min_u32 s19, s22, -2
  v_mov_b32 v202, s19
  buffer_store_dword v202, v201, s[12:15], s78 offen sc1
  s_mov_b32 s78, 0
L_lw4:
  ds_read_b32 v61, v38 offset:4
  s_waitcnt lgkmcnt(0)
  v_readfirstlane_b32 s79, v61
  s_nop 0
  s_cmp_ge_u32 s79, 1
  s_nop 1
  s_cbranch_scc1 L_lwd4
  s_add_u32 s78, s78, 1
  s_cmp_gt_u32 s78, 0x400000
  s_cbranch_scc1 L_end
  s_sleep 8
  s_branch L_lw4
L_lwd4:
  s_mov_b32 s78, 0
L_lw5:
  ds_read_b32 v61, v38 offset:0
  s_waitcnt lgkmcnt(0)
  v_readfirstlane_b32 s79, v61
  s_nop 0
  s_cmp_ge_u32 s79, 56
  s_nop 1
  s_cbranch_scc1 L_lwd5
  s_add_u32 s78, s78, 1
  s_cmp_gt_u32 s78, 0x400000
  s_cbranch_scc1 L_end
  s_sleep 8
  s_branch L_lw5
L_lwd5:
  s_mov_b32 s79, 208896
  s_memrealtime s[22:23]
  buffer_load_dword v208, v3, s[12:15], s79 offen offset:0 sc1
  buffer_load_dword v209, v3, s[12:15], s79 offen offset:1024 sc1
  buffer_load_dword v210, v3, s[12:15], s79 offen offset:2048 sc1
  buffer_load_dword v211, v3, s[12:15], s79 offen offset:3072 sc1
  ds_read_b32 v213, v38 offset:0
  s_waitcnt vmcnt(0) lgkmcnt(0)
  v_mov_b32 v212, s22
  v_cmp_eq_u32 vcc, -1, v208
  s_nop 1
  v_cndmask_b32 v208, v208, v212, vcc
  v_subrev_u32 v208, s19, v208
  v_cvt_f32_i32 v208, v208
  v_cmp_eq_u32 vcc, -1, v209
  s_nop 1
  v_cndmask_b32 v209, v209, v212, vcc
  v_subrev_u32 v209, s19, v209
  v_cvt_f32_i32 v209, v209
  v_cmp_eq_u32 vcc, -1, v210
  s_nop 1
  v_cndmask_b32 v210, v210, v212, vcc
  v_subrev_u32 v210, s19, v210
  v_cvt_f32_i32 v210, v210
  v_cmp_eq_u32 vcc, -1, v211
  s_nop 1
  v_cndmask_b32 v211, v211, v212, vcc
  v_subrev_u32 v211, s19, v211
  v_cvt_f32_i32 v211, v211
  v_add_f32 v208, v208, v209
  v_add_f32 v210, v210, v211
  v_add_f32 v208, v208, v210
  s_nop 1
  v_add_f32_dpp v208, v208, v208 row_ror:8 row_mask:0xf bank_mask:0xf
  s_nop 1
  v_add_f32_dpp v208, v208, v208 row_ror:4 row_mask:0xf bank_mask:0xf
  s_nop 1
  v_add_f32_dpp v208, v208, v208 row_ror:2 row_mask:0xf bank_mask:0xf
  s_nop 1
  v_add_f32_dpp v208, v208, v208 row_ror:1 row_mask:0xf bank_mask:0xf
  v_mov_b32 v209, v208
  s_nop 1
  v_permlane16_swap_b32 v209, v208
  v_add_f32 v208, v208, v209
  v_mov_b32 v209, v208
  s_nop 1
  v_permlane32_swap_b32 v209, v208
  v_add_f32 v208, v208, v209
  v_fmac_f32 v214, 3145728000, v208
  v_add_f32 v215, 0, v214
  v_mul_f32 v215, 3193939008, v215
  v_mul_f32 v214, 1044623288, v214
  v_max_f32 v214, 0, v214
  v_max_f32 v215, 0, v215
  v_cvt_u32_f32 v214, v214
  v_cvt_u32_f32 v215, v215
  v_add_u32 v214, v214, v213
  v_add_u32 v215, v215, v213
  s_mov_b64 exec, 1
  ds_write_b64 v38, v[214:215] offset:40
  s_mov_b64 exec, -1
  s_waitcnt lgkmcnt(0)
  s_mov_b32 s78, 0
L_lw6:
  ds_read_b32 v61, v38 offset:32
  s_waitcnt lgkmcnt(0)
  v_readfirstlane_b32 s79, v61
  s_nop 0
  s_cmp_ge_u32 s79, 256
  s_nop 1
  s_cbranch_scc1 L_lwd6
  s_add_u32 s78, s78, 1
  s_cmp_gt_u32 s78, 0x400000
  s_cbranch_scc1 L_end
  s_sleep 8
  s_branch L_lw6
L_lwd6:
  v_add_u32 v176, 107520, v3
  s_mov_b32 s78, 1069066811
  ds_read_b128 v[160:163], v176 offset:0
  ds_read_b128 v[164:167], v176 offset:1024
  ds_read_b128 v[168:171], v176 offset:2048
  ds_read_b128 v[172:175], v176 offset:3072
  s_waitcnt vmcnt(0) lgkmcnt(0)
  v_lshlrev_b32 v224, 16, v160
  v_and_b32 v225, 0xffff0000, v160
  v_lshlrev_b32 v226, 16, v161
  v_and_b32 v227, 0xffff0000, v161
  v_lshlrev_b32 v228, 16, v162
  v_and_b32 v229, 0xffff0000, v162
  v_lshlrev_b32 v230, 16, v163
  v_and_b32 v231, 0xffff0000, v163
  v_lshlrev_b32 v232, 16, v164
  v_and_b32 v233, 0xffff0000, v164
  v_lshlrev_b32 v234, 16, v165
  v_and_b32 v235, 0xffff0000, v165
  v_lshlrev_b32 v236, 16, v166
  v_and_b32 v237, 0xffff0000, v166
  v_lshlrev_b32 v238, 16, v167
  v_and_b32 v239, 0xffff0000, v167
  v_lshlrev_b32 v240, 16, v168
  v_and_b32 v241, 0xffff0000, v168
  v_lshlrev_b32 v242, 16, v169
  v_and_b32 v243, 0xffff0000, v169
  v_lshlrev_b32 v244, 16, v170
  v_and_b32 v245, 0xffff0000, v170
  v_lshlrev_b32 v246, 16, v171
  v_and_b32 v247, 0xffff0000, v171
  v_lshlrev_b32 v248, 16, v172
  v_and_b32 v249, 0xffff0000, v172
  v_lshlrev_b32 v250, 16, v173
  v_and_b32 v251, 0xffff0000, v173
  v_lshlrev_b32 v252, 16, v174
  v_and_b32 v253, 0xffff0000, v174
  v_lshlrev_b32 v254, 16, v175
  v_and_b32 v255, 0xffff0000, v175
  v_max_f32 v181, v224, v225
  v_max3_f32 v181, v181, v226, v227
  v_max3_f32 v181, v181, v228, v229
  v_max3_f32 v181, v181, v230, v231
  v_max3_f32 v181, v181, v232, v233
  v_max3_f32 v181, v181, v234, v235
  v_max3_f32 v181, v181, v236, v237
  v_max3_f32 v181, v181, v238, v239
  v_max3_f32 v181, v181, v240, v241
  v_max3_f32 v181, v181, v242, v243
  v_max3_f32 v181, v181, v244, v245
  v_max3_f32 v181, v181, v246, v247
  v_max3_f32 v181, v181, v248, v249
  v_max3_f32 v181, v181, v250, v251
  v_max3_f32 v181, v181, v252, v253
  v_max3_f32 v181, v181, v254, v255
  s_nop 1
  v_max_f32_dpp v181, v181, v181 row_ror:8 row_mask:0xf bank_mask:0xf
  s_nop 1
  v_max_f32_dpp v181, v181, v181 row_ror:4 row_mask:0xf bank_mask:0xf
  s_nop 1
  v_max_f32_dpp v181, v181, v181 row_ror:2 row_mask:0xf bank_mask:0xf
  s_nop 1
  v_max_f32_dpp v181, v181, v181 row_ror:1 row_mask:0xf bank_mask:0xf
  v_mov_b32 v177, v181
  s_nop 1
  v_permlane16_swap_b32 v177, v181
  v_max_f32 v181, v181, v177
  v_mov_b32 v177, v181
  s_nop 1
  v_permlane32_swap_b32 v177, v181
  v_max_f32 v181, v181, v177
  v_sub_f32 v224, v224, v181
  v_sub_f32 v225, v225, v181
  v_sub_f32 v226, v226, v181
  v_sub_f32 v227, v227, v181
  v_sub_f32 v228, v228, v181
  v_sub_f32 v229, v229, v181
  v_sub_f32 v230, v230, v181
  v_sub_f32 v231, v231, v181
  v_sub_f32 v232, v232, v181
  v_sub_f32 v233, v233, v181
  v_sub_f32 v234, v234, v181
  v_sub_f32 v235, v235, v181
  v_sub_f32 v236, v236, v181
  v_sub_f32 v237, v237, v181
  v_sub_f32 v238, v238, v181
  v_sub_f32 v239, v239, v181
  v_sub_f32 v240, v240, v181
  v_sub_f32 v241, v241, v181
  v_sub_f32 v242, v242, v181
  v_sub_f32 v243, v243, v181
  v_sub_f32 v244, v244, v181
  v_sub_f32 v245, v245, v181
  v_sub_f32 v246, v246, v181
  v_sub_f32 v247, v247, v181
  v_sub_f32 v248, v248, v181
  v_sub_f32 v249, v249, v181
  v_sub_f32 v250, v250, v181
  v_sub_f32 v251, v251, v181
  v_sub_f32 v252, v252, v181
  v_sub_f32 v253, v253, v181
  v_sub_f32 v254, v254, v181
  v_sub_f32 v255, v255, v181
  v_mul_f32 v224, s78, v224
  v_mul_f32 v225, s78, v225
  v_mul_f32 v226, s78, v226
  v_mul_f32 v227, s78, v227
  v_mul_f32 v228, s78, v228
  v_mul_f32 v229, s78, v229
  v_mul_f32 v230, s78, v230
  v_mul_f32 v231, s78, v231
  v_mul_f32 v232, s78, v232
  v_mul_f32 v233, s78, v233
  v_mul_f32 v234, s78, v234
  v_mul_f32 v235, s78, v235
  v_mul_f32 v236, s78, v236
  v_mul_f32 v237, s78, v237
  v_mul_f32 v238, s78, v238
  v_mul_f32 v239, s78, v239
  v_mul_f32 v240, s78, v240
  v_mul_f32 v241, s78, v241
  v_mul_f32 v242, s78, v242
  v_mul_f32 v243, s78, v243
  v_mul_f32 v244, s78, v244
  v_mul_f32 v245, s78, v245
  v_mul_f32 v246, s78, v246
  v_mul_f32 v247, s78, v247
  v_mul_f32 v248, s78, v248
  v_mul_f32 v249, s78, v249
  v_mul_f32 v250, s78, v250
  v_mul_f32 v251, s78, v251
  v_mul_f32 v252, s78, v252
  v_mul_f32 v253, s78, v253
  v_mul_f32 v254, s78, v254
  v_mul_f32 v255, s78, v255
  v_exp_f32 v224, v224
  v_exp_f32 v225, v225
  v_exp_f32 v226, v226
  v_exp_f32 v227, v227
  v_exp_f32 v228, v228
  v_exp_f32 v229, v229
  v_exp_f32 v230, v230
  v_exp_f32 v231, v231
  v_exp_f32 v232, v232
  v_exp_f32 v233, v233
  v_exp_f32 v234, v234
  v_exp_f32 v235, v235
  v_exp_f32 v236, v236
  v_exp_f32 v237, v237
  v_exp_f32 v238, v238
  v_exp_f32 v239, v239
  v_exp_f32 v240, v240
  v_exp_f32 v241, v241
  v_exp_f32 v242, v242
  v_exp_f32 v243, v243
  v_exp_f32 v244, v244
  v_exp_f32 v245, v245
  v_exp_f32 v246, v246
  v_exp_f32 v247, v247
  v_exp_f32 v248, v248
  v_exp_f32 v249, v249
  v_exp_f32 v250, v250
  v_exp_f32 v251, v251
  v_exp_f32 v252, v252
  v_exp_f32 v253, v253
  v_exp_f32 v254, v254
  v_exp_f32 v255, v255
  v_add_f32 v224, v224, v225
  v_add_f32 v226, v226, v227
  v_add_f32 v228, v228, v229
  v_add_f32 v230, v230, v231
  v_add_f32 v232, v232, v233
  v_add_f32 v234, v234, v235
  v_add_f32 v236, v236, v237
  v_add_f32 v238, v238, v239
  v_add_f32 v240, v240, v241
  v_add_f32 v242, v242, v243
  v_add_f32 v244, v244, v245
  v_add_f32 v246, v246, v247
  v_add_f32 v248, v248, v249
  v_add_f32 v250, v250, v251
  v_add_f32 v252, v252, v253
  v_add_f32 v254, v254, v255
  v_add_f32 v224, v224, v226
  v_add_f32 v228, v228, v230
  v_add_f32 v232, v232, v234
  v_add_f32 v236, v236, v238
  v_add_f32 v240, v240, v242
  v_add_f32 v244, v244, v246
  v_add_f32 v248, v248, v250
  v_add_f32 v252, v252, v254
  v_add_f32 v224, v224, v228
  v_add_f32 v232, v232, v236
  v_add_f32 v240, v240, v244
  v_add_f32 v248, v248, v252
  v_add_f32 v224, v224, v232
  v_add_f32 v240, v240, v248
  v_add_f32 v224, v224, v240
  v_mov_b32 v182, v224
  s_nop 1
  v_add_f32_dpp v182, v182, v182 row_ror:8 row_mask:0xf bank_mask:0xf
  s_nop 1
  v_add_f32_dpp v182, v182, v182 row_ror:4 row_mask:0xf bank_mask:0xf
  s_nop 1
  v_add_f32_dpp v182, v182, v182 row_ror:2 row_mask:0xf bank_mask:0xf
  s_nop 1
  v_add_f32_dpp v182, v182, v182 row_ror:1 row_mask:0xf bank_mask:0xf
  v_mov_b32 v177, v182
  s_nop 1
  v_permlane16_swap_b32 v177, v182
  v_add_f32 v182, v182, v177
  v_mov_b32 v177, v182
  s_nop 1
  v_permlane32_swap_b32 v177, v182
  v_add_f32 v182, v182, v177
  v_min_u32 v181, -2, v181
  v_min_u32 v182, -2, v182
  v_mov_b32 v180, v181
  v_mov_b32 v181, v182
  buffer_store_dwordx2 v[180:181], v201, s[12:15], 0 offen sc1
  s_mov_b32 s78, 0
L_lw7:
  ds_read_b32 v61, v38 offset:4
  s_waitcnt lgkmcnt(0)
  v_readfirstlane_b32 s79, v61
  s_nop 0
  s_cmp_ge_u32 s79, 1
  s_nop 1
  s_cbranch_scc1 L_lwd7
  s_add_u32 s78, s78, 1
  s_cmp_gt_u32 s78, 0x400000
  s_cbranch_scc1 L_end
  s_sleep 8
  s_branch L_lw7
L_lwd7:
  s_mov_b32 s78, 0
L_lw8:
  ds_read_b32 v61, v38 offset:0
  s_waitcnt lgkmcnt(0)
  v_readfirstlane_b32 s79, v61
  s_nop 0
  s_cmp_ge_u32 s79, 84
  s_nop 1
  s_cbranch_scc1 L_lwd8
  s_add_u32 s78, s78, 1
  s_cmp_gt_u32 s78, 0x400000
  s_cbranch_scc1 L_end
  s_sleep 8
  s_branch L_lw8
L_lwd8:
  s_mov_b32 s78, 0
L_poll9:
  buffer_load_dwordx2 v[184:185], v200, s[12:15], 0 offen sc1
  s_waitcnt vmcnt(0)
  v_max_u32 v190, v184, v185
  v_cmp_eq_u32 vcc, -1, v190
  s_nop 3
  s_cbranch_vccz L_pdone9
  s_add_u32 s78, s78, 1
  s_cmp_gt_u32 s78, 0x100000
  s_cbranch_scc1 L_end
  s_sleep 16
  s_branch L_poll9
L_pdone9:
  s_mov_b32 s78, 1069066811
  v_max_f32_dpp v188, v184, v184 quad_perm:[1,0,3,2] row_mask:0xf bank_mask:0xf
  s_nop 1
  v_max_f32_dpp v188, v188, v188 quad_perm:[2,3,0,1] row_mask:0xf bank_mask:0xf
  v_sub_f32 v184, v184, v188
  v_mul_f32 v184, s78, v184
  v_exp_f32 v184, v184
  s_nop 0
  v_mul_f32 v189, v184, v185
  s_nop 1
  v_add_f32_dpp v189, v189, v189 quad_perm:[1,0,3,2] row_mask:0xf bank_mask:0xf
  s_nop 1
  v_add_f32_dpp v189, v189, v189 quad_perm:[2,3,0,1] row_mask:0xf bank_mask:0xf
  v_rcp_f32 v189, v189
  v_mov_b32 v204, 128
  s_mov_b64 exec, 1
  ds_write_b64 v38, v[188:189] offset:24
  ds_write_b32 v38, v204 offset:16
  s_mov_b64 exec, -1
  s_waitcnt lgkmcnt(0)
  s_mov_b32 s78, 0
L_lw10:
  ds_read_b32 v61, v38 offset:0
  s_waitcnt lgkmcnt(0)
  v_readfirstlane_b32 s79, v61
  s_nop 0
  s_cmp_ge_u32 s79, 90
  s_nop 1
  s_cbranch_scc1 L_lwd10
  s_add_u32 s78, s78, 1
  s_cmp_gt_u32 s78, 0x400000
  s_cbranch_scc1 L_end
  s_sleep 2
  s_branch L_lw10
L_lwd10:
  s_memrealtime s[22:23]
  v_mov_b32 v214, 0
  s_mov_b32 s78, 8192
  s_waitcnt lgkmcnt(0)
  s_add_u32 s22, s22, s18
  s_min_u32 s19, s22, -2
  v_mov_b32 v202, s19
  buffer_store_dword v202, v201, s[12:15], s78 offen sc1
  s_getpc_b64 s[16:17]
L_pcB:
  s_sub_u32 s16, s16, L_pcB-sequential_preLN__gqa_block_cached__geglu_ffn__decode_kernel
  s_subb_u32 s17, s17, 0
  s_lshl_b32 s79, s65, 1
  s_add_u32 s79, s79, s3
  s_sub_u32 s79, s79, 6
  s_and_b32 s79, s79, 31
  s_lshl_b32 s79, s79, 10
  v_add_u32 v220, s79, v3
  v_min_u32 v220, L_end-sequential_preLN__gqa_block_cached__geglu_ffn__decode_kernel-16, v220
  v_and_b32 v220, -16, v220
  v_mov_b32 v221, s17
  v_add_co_u32 v220, vcc, s16, v220
  s_nop 1
  v_addc_co_u32 v221, vcc, 0, v221, vcc
  global_load_dwordx4 v[216:219], v[220:221], off
  s_add_u32 s79, s79, 1024
  v_add_u32 v220, s79, v3
  v_min_u32 v220, L_end-sequential_preLN__gqa_block_cached__geglu_ffn__decode_kernel-16, v220
  v_and_b32 v220, -16, v220
  v_mov_b32 v221, s17
  v_add_co_u32 v220, vcc, s16, v220
  s_nop 1
  v_addc_co_u32 v221, vcc, 0, v221, vcc
  global_load_dwordx4 v[216:219], v[220:221], off
  s_add_u32 s79, s79, 1024
  s_mov_b32 s78, 0
  s_nop 1
L_lw11:
  ds_read_b32 v61, v38 offset:0
  s_waitcnt lgkmcnt(0)
  v_readfirstlane_b32 s79, v61
  s_nop 0
  s_cmp_ge_u32 s79, 97
  s_nop 1
  s_cbranch_scc1 L_lwd11
  s_add_u32 s78, s78, 1
  s_cmp_gt_u32 s78, 0x400000
  s_cbranch_scc1 L_end
  s_sleep 8
  s_branch L_lw11
L_lwd11:
  s_mov_b32 s79, 212992
  s_memrealtime s[22:23]
  buffer_load_dword v208, v3, s[12:15], s79 offen offset:0 sc1
  buffer_load_dword v209, v3, s[12:15], s79 offen offset:1024 sc1
  buffer_load_dword v210, v3, s[12:15], s79 offen offset:2048 sc1
  buffer_load_dword v211, v3, s[12:15], s79 offen offset:3072 sc1
  ds_read_b32 v213, v38 offset:0
  s_waitcnt vmcnt(0) lgkmcnt(0)
  v_mov_b32 v212, s22
  v_cmp_eq_u32 vcc, -1, v208
  s_nop 1
  v_cndmask_b32 v208, v208, v212, vcc
  v_subrev_u32 v208, s19, v208
  v_cvt_f32_i32 v208, v208
  v_cmp_eq_u32 vcc, -1, v209
  s_nop 1
  v_cndmask_b32 v209, v209, v212, vcc
  v_subrev_u32 v209, s19, v209
  v_cvt_f32_i32 v209, v209
  v_cmp_eq_u32 vcc, -1, v210
  s_nop 1
  v_cndmask_b32 v210, v210, v212, vcc
  v_subrev_u32 v210, s19, v210
  v_cvt_f32_i32 v210, v210
  v_cmp_eq_u32 vcc, -1, v211
  s_nop 1
  v_cndmask_b32 v211, v211, v212, vcc
  v_subrev_u32 v211, s19, v211
  v_cvt_f32_i32 v211, v211
  v_add_f32 v208, v208, v209
  v_add_f32 v210, v210, v211
  v_add_f32 v208, v208, v210
  s_nop 1
  v_add_f32_dpp v208, v208, v208 row_ror:8 row_mask:0xf bank_mask:0xf
  s_nop 1
  v_add_f32_dpp v208, v208, v208 row_ror:4 row_mask:0xf bank_mask:0xf
  s_nop 1
  v_add_f32_dpp v208, v208, v208 row_ror:2 row_mask:0xf bank_mask:0xf
  s_nop 1
  v_add_f32_dpp v208, v208, v208 row_ror:1 row_mask:0xf bank_mask:0xf
  v_mov_b32 v209, v208
  s_nop 1
  v_permlane16_swap_b32 v209, v208
  v_add_f32 v208, v208, v209
  v_mov_b32 v209, v208
  s_nop 1
  v_permlane32_swap_b32 v209, v208
  v_add_f32 v208, v208, v209
  v_fmac_f32 v214, 3145728000, v208
  v_add_f32 v215, 0, v214
  v_mul_f32 v215, 3191984798, v215
  v_mul_f32 v214, 1042913354, v214
  v_max_f32 v214, 0, v214
  v_max_f32 v215, 0, v215
  v_cvt_u32_f32 v214, v214
  v_cvt_u32_f32 v215, v215
  v_add_u32 v214, v214, v213
  v_add_u32 v215, v215, v213
  s_mov_b64 exec, 1
  ds_write_b64 v38, v[214:215] offset:40
  s_mov_b64 exec, -1
  s_waitcnt lgkmcnt(0)
  s_setpc_b64 s[20:21]
L_hasrole:
  s_setprio 0
  s_mov_b32 s77, 1069066811
  v_bfe_u32 v6, v1, 2, 2
  v_lshl_add_u32 v6, v4, 3, v6
  v_and_b32 v7, 3, v1
  s_cmp_ge_u32 s71, 80
  s_cbranch_scc1 L_role_gu
  s_lshl_b32 s70, s3, 13
  v_lshlrev_b32 v8, 7, v6
  v_lshl_add_u32 v8, v7, 3, v8
  v_add_u32 v8, s70, v8
  s_mul_i32 s72, s71, 6554
  s_lshr_b32 s72, s72, 16
  s_mul_i32 s73, s72, 10
  s_sub_u32 s73, s71, s73
  s_lshl_b32 s74, s72, 2
  s_lshr_b32 s75, s3, 1
  s_add_u32 s74, s74, s75
  s_mul_i32 s75, s74, 2048
  s_and_b32 s76, s3, 1
  s_lshl_b32 s76, s76, 7
  s_add_u32 s76, s76, s75
  v_lshrrev_b32 v12, 3, v1
  v_and_b32 v13, 7, v1
  v_mul_u32_u24 v9, 256, v12
  v_lshl_add_u32 v9, v13, 4, v9
  s_mul_i32 s70, s3, 1152
  s_add_u32 s70, s70, 84480
  v_mul_u32_u24 v15, 144, v12
  v_lshl_add_u32 v15, v13, 4, v15
  v_add_u32 v15, s70, v15
  v_mul_u32_u24 v16, 144, v13
  v_lshl_add_u32 v16, v4, 4, v16
  v_add_u32 v16, s70, v16
  v_mov_b32 v40, 0
  v_mov_b32 v41, 0
  v_and_b32 v10, 1, v4
  v_lshl_add_u32 v29, v10, 2, v7
  v_mul_u32_u24 v29, 256, v29
  v_lshrrev_b32 v30, 1, v4
  v_lshl_add_u32 v30, v10, 2, v30
  v_lshl_add_u32 v30, v30, 4, v5
  v_lshlrev_b32 v30, 5, v30
  s_lshl_b32 s70, s3, 2
  s_add_u32 s70, s70, 76288
  v_add_u32 v30, s70, v30
  v_lshlrev_b32 v11, 6, v1
  v_add_u32 v11, 76288, v11
  s_lshl_b32 s73, s73, 4
  s_add_u32 s72, s72, s73
  s_mul_i32 s72, s72, 128
  s_add_u32 s72, s72, 131072
  v_lshrrev_b32 v28, 5, v1
  v_lshlrev_b32 v28, 6, v28
  v_mul_u32_u24 v31, 1024, v10
  v_add_u32 v28, v28, v31
  v_lshl_add_u32 v28, v5, 2, v28
  s_mov_b32 s34, 0
  s_mov_b32 s35, -1
  s_cmp_lt_u32 s3, 4
  s_cbranch_scc1 L_wrW
  s_mov_b32 s24, s48
  s_mov_b32 s25, s49
  s_mov_b32 s26, 5242880
  s_mov_b32 s27, 0x20000
  v_lshrrev_b32 v60, 3, v1
  v_mul_u32_u24 v60, 1280, v60
  v_and_b32 v61, 7, v1
  v_lshl_add_u32 v60, v61, 4, v60
  s_mul_i32 s28, s71, 6554
  s_lshr_b32 s28, s28, 16
  s_mul_i32 s29, s28, 10
  s_sub_u32 s29, s71, s29
  s_lshl_b32 s28, s28, 2
  s_add_u32 s28, s28, s69
  s_mul_i32 s28, s28, 163840
  s_lshl_b32 s29, s29, 7
  s_add_u32 s28, s28, s29
  s_lshl_b32 s30, s69, 14
  s_and_b32 s31, s71, 0
  s_cmp_lg_u32 s3, 6
  s_cbranch_scc1 L_nbW
  s_call_b64 s[20:21], L_balance
L_nbW:
  s_mov_b32 s78, 0
L_lw12:
  ds_read_b32 v61, v38 offset:16
  s_waitcnt lgkmcnt(0)
  v_readfirstlane_b32 s79, v61
  s_nop 0
  s_cmp_ge_u32 s79, 1
  s_nop 1
  s_cbranch_scc1 L_lwd12
  s_add_u32 s78, s78, 1
  s_cmp_gt_u32 s78, 0x400000
  s_cbranch_scc1 L_end
  s_sleep 8
  s_branch L_lw12
L_lwd12:
  s_add_u32 s22, s79, 2
  s_mov_b32 s78, 0
L_lw13:
  ds_read_b32 v61, v38 offset:0
  s_waitcnt lgkmcnt(0)
  v_readfirstlane_b32 s79, v61
  s_nop 0
  s_cmp_ge_u32 s79, s22
  s_nop 1
  s_cbranch_scc1 L_lwd13
  s_add_u32 s78, s78, 1
  s_cmp_gt_u32 s78, 0x400000
  s_cbranch_scc1 L_end
  s_sleep 2
  s_branch L_lw13
L_lwd13:
  s_add_u32 m0, s30, 0
  s_add_u32 s79, s28, 0
  buffer_load_dwordx4 v60, s[24:27], s79 offen nt lds
  s_add_u32 m0, s30, 1024
  s_add_u32 s79, s28, 10240
  buffer_load_dwordx4 v60, s[24:27], s79 offen nt lds
  s_add_u32 m0, s30, 2048
  s_add_u32 s79, s28, 20480
  buffer_load_dwordx4 v60, s[24:27], s79 offen nt lds
  s_add_u32 m0, s30, 3072
  s_add_u32 s79, s28, 30720
  buffer_load_dwordx4 v60, s[24:27], s79 offen nt lds
  s_add_u32 m0, s30, 4096
  s_add_u32 s79, s28, 40960
  buffer_load_dwordx4 v60, s[24:27], s79 offen nt lds
  s_add_u32 m0, s30, 5120
  s_add_u32 s79, s28, 51200
  buffer_load_dwordx4 v60, s[24:27], s79 offen nt lds
  s_add_u32 m0, s30, 6144
  s_add_u32 s79, s28, 61440
  buffer_load_dwordx4 v60, s[24:27], s79 offen nt lds
  s_add_u32 m0, s30, 7168
  s_add_u32 s79, s28, 71680
  buffer_load_dwordx4 v60, s[24:27], s79 offen nt lds
  s_add_u32 m0, s30, 8192
  s_add_u32 s79, s28, 81920
  buffer_load_dwordx4 v60, s[24:27], s79 offen nt lds
  s_add_u32 m0, s30, 9216
  s_add_u32 s79, s28, 92160
  buffer_load_dwordx4 v60, s[24:27], s79 offen nt lds
  s_add_u32 m0, s30, 10240
  s_add_u32 s79, s28, 102400
  buffer_load_dwordx4 v60, s[24:27], s79 offen nt lds
  s_add_u32 m0, s30, 11264
  s_add_u32 s79, s28, 112640
  buffer_load_dwordx4 v60, s[24:27], s79 offen nt lds
  s_add_u32 m0, s30, 12288
  s_add_u32 s79, s28, 122880
  buffer_load_dwordx4 v60, s[24:27], s79 offen nt lds
  s_add_u32 m0, s30, 13312
  s_add_u32 s79, s28, 133120
  buffer_load_dwordx4 v60, s[24:27], s79 offen nt lds
  s_add_u32 m0, s30, 14336
  s_add_u32 s79, s28, 143360
  buffer_load_dwordx4 v60, s[24:27], s79 offen nt lds
  s_add_u32 m0, s30, 15360
  s_add_u32 s79, s28, 153600
  buffer_load_dwordx4 v60, s[24:27], s79 offen nt lds
  s_waitcnt vmcnt(0)
L_wrW:
  s_barrier
  s_mov_b32 s78, 0
  buffer_load_dwordx4 v[44:47], v9, s[12:15], s76 offen sc1
  ds_read_b64_tr_b16 v[64:65], v8 offset:0
  ds_read_b64_tr_b16 v[66:67], v8 offset:512
  ds_read_b64_tr_b16 v[68:69], v8 offset:32
  ds_read_b64_tr_b16 v[70:71], v8 offset:544
  ds_read_b64_tr_b16 v[72:73], v8 offset:64
  ds_read_b64_tr_b16 v[74:75], v8 offset:576
  ds_read_b64_tr_b16 v[76:77], v8 offset:96
  ds_read_b64_tr_b16 v[78:79], v8 offset:608
  s_waitcnt lgkmcnt(4)
  ds_read_b64_tr_b16 v[80:81], v8 offset:4096
  ds_read_b64_tr_b16 v[82:83], v8 offset:4608
  ds_read_b64_tr_b16 v[84:85], v8 offset:4128
  ds_read_b64_tr_b16 v[86:87], v8 offset:4640
  ds_read_b64_tr_b16 v[88:89], v8 offset:4160
  ds_read_b64_tr_b16 v[90:91], v8 offset:4672
  ds_read_b64_tr_b16 v[92:93], v8 offset:4192
  ds_read_b64_tr_b16 v[94:95], v8 offset:4704
  s_waitcnt lgkmcnt(0)
  s_branch L_pw14
L_poll14:
  buffer_load_dwordx4 v[44:47], v9, s[12:15], s76 offen sc1
L_pw14:
  s_waitcnt vmcnt(0)
  ds_write_b128 v15, v[44:47]
  ds_read_b128 v[32:35], v16
  ds_read_b128 v[36:39], v16 offset:64
  v_max3_u32 v12, v44, v45, v46
  v_max_u32 v12, v12, v47
  v_cmp_eq_u32 vcc, -1, v12
  s_nop 3
  s_cbranch_vccz L_pdone14
  s_add_u32 s78, s78, 1
  s_cmp_gt_u32 s78, 0x100000
  s_cbranch_scc1 L_end
  s_sleep 1
  s_branch L_poll14
L_pdone14:
  s_waitcnt lgkmcnt(1)
  v_mfma_f32_16x16x32_bf16 v[96:99], v[32:35], v[64:67], 0
  v_mfma_f32_16x16x32_bf16 v[100:103], v[32:35], v[68:71], 0
  v_mfma_f32_16x16x32_bf16 v[104:107], v[32:35], v[72:75], 0
  v_mfma_f32_16x16x32_bf16 v[108:111], v[32:35], v[76:79], 0
  s_waitcnt lgkmcnt(0)
  v_mfma_f32_16x16x32_bf16 v[96:99], v[36:39], v[80:83], v[96:99]
  v_mfma_f32_16x16x32_bf16 v[100:103], v[36:39], v[84:87], v[100:103]
  v_mfma_f32_16x16x32_bf16 v[104:107], v[36:39], v[88:91], v[104:107]
  v_mfma_f32_16x16x32_bf16 v[108:111], v[36:39], v[92:95], v[108:111]
  s_nop 4
  v_add_f32 v96, v96, v97
  v_add_f32 v98, v98, v99
  v_add_f32 v100, v100, v101
  v_add_f32 v102, v102, v103
  v_add_f32 v104, v104, v105
  v_add_f32 v106, v106, v107
  v_add_f32 v108, v108, v109
  v_add_f32 v110, v110, v111
  v_cndmask_b32 v20, v96, v100, s[34:35]
  v_cndmask_b32 v21, v98, v102, s[34:35]
  v_cndmask_b32 v22, v104, v108, s[34:35]
  v_cndmask_b32 v23, v106, v110, s[34:35]
  v_add_f32 v20, v20, v21
  v_add_f32 v22, v22, v23
  ds_write_b32 v30, v20
  ds_write_b32 v30, v22 offset:1024
  s_waitcnt lgkmcnt(0)
  s_barrier
  s_cmp_lg_u32 s3, 0
  s_cbranch_scc1 L_fin
  ds_read_b128 v[32:35], v11 offset:0
  ds_read_b128 v[36:39], v11 offset:16
  ds_read_b128 v[40:43], v11 offset:32
  ds_read_b128 v[44:47], v11 offset:48
  s_waitcnt lgkmcnt(0)
  v_add_f32 v32, v32, v33
  v_add_f32 v34, v34, v35
  v_add_f32 v36, v36, v37
  v_add_f32 v38, v38, v39
  v_add_f32 v40, v40, v41
  v_add_f32 v42, v42, v43
  v_add_f32 v44, v44, v45
  v_add_f32 v46, v46, v47
  v_add_f32 v32, v32, v34
  v_add_f32 v36, v36, v38
  v_add_f32 v40, v40, v42
  v_add_f32 v44, v44, v46
  v_add_f32 v32, v32, v36
  v_add_f32 v40, v40, v44
  v_cvt_pk_bf16_f32 v20, v32, v40
  v_min_u32 v20, -2, v20
  s_nop 1
  v_mov_b32_dpp v21, v20 quad_perm:[1,1,1,1] row_mask:0xf bank_mask:0xf
  v_mov_b32_dpp v22, v20 quad_perm:[2,2,2,2] row_mask:0xf bank_mask:0xf
  v_mov_b32_dpp v23, v20 quad_perm:[3,3,3,3] row_mask:0xf bank_mask:0xf
  s_mov_b32 exec_lo, 0x11111111
  s_mov_b32 exec_hi, 0x11111111
  buffer_store_dwordx4 v[20:23], v28, s[12:15], s72 offen sc1
  s_mov_b64 exec, -1
  s_branch L_fin
L_role_gu:
  v_lshlrev_b32 v8, 5, v6
  v_lshl_add_u32 v8, v7, 3, v8
  s_cmp_ge_u32 s71, 188
  s_cbranch_scc1 L_role_dn
  s_and_b32 s73, s3, 3
  s_mul_i32 s70, s73, 10240
  v_lshlrev_b32 v8, 6, v6
  v_lshl_add_u32 v8, v7, 3, v8
  v_add_u32 v8, s70, v8
  s_sub_u32 s79, s71, 80
  s_lshr_b32 s32, s79, 2
  s_lshl_b32 s32, s32, 1
  s_and_b32 s33, s79, 1
  s_add_u32 s32, s32, s33
  s_bfe_u32 s33, s79, 0x10001
  s_mul_i32 s72, s73, 320
  v_lshrrev_b32 v10, 3, v5
  v_mul_u32_u24 v10, 1280, v10
  v_lshl_add_u32 v10, v4, 4, v10
  v_and_b32 v12, 7, v1
  v_mul_u32_u24 v9, 144, v12
  v_lshrrev_b32 v13, 3, v5
  v_lshl_add_u32 v9, v13, 6, v9
  v_lshl_add_u32 v9, v4, 4, v9
  s_mul_i32 s70, s73, 5760
  s_add_u32 s70, s70, 84480
  v_add_u32 v9, s70, v9
  v_lshrrev_b32 v13, 3, v1
  v_mul_u32_u24 v17, 144, v13
  v_lshl_add_u32 v17, v12, 4, v17
  v_add_u32 v17, s70, v17
  s_add_u32 s70, s72, 81408
  v_add_u32 v10, s70, v10
  ds_read_b128 v[104:107], v10 offset:0
  ds_read_b128 v[108:111], v10 offset:64
  ds_read_b128 v[112:115], v10 offset:128
  ds_read_b128 v[116:119], v10 offset:192
  ds_read_b128 v[120:123], v10 offset:256
  s_mul_i32 s72, s73, 5120
  s_add_u32 s72, s72, 131072
  v_lshrrev_b32 v19, 3, v1
  v_mul_u32_u24 v19, 128, v19
  v_lshl_add_u32 v19, v12, 4, v19
  v_cmp_eq_u32 s[34:35], 0, v12
  v_cmp_eq_u32 s[36:37], 1, v12
  v_mov_b32 v18, 0
  v_lshlrev_b32 v11, 4, v1
  v_add_u32 v11, 76288, v11
  s_lshl_b32 s70, s73, 2
  v_add_u32 v30, s70, v11
  v_lshrrev_b32 v13, 1, v4
  v_lshlrev_b32 v31, 6, v13
  v_add_u32 v31, 75952, v31
  v_lshlrev_b32 v14, 3, v13
  v_cmp_eq_u32 vcc, v14, v5
  v_and_b32 v14, 1, v4
  v_lshl_add_u32 v14, v14, 3, v31
  s_lshl_b32 s70, s73, 4
  v_add_u32 v14, s70, v14
  v_mov_b32 v15, 76080
  v_cndmask_b32 v29, v15, v14, vcc
  v_lshlrev_b32 v28, 1, v1
  v_mov_b32 v124, 1065369472
  v_mov_b32 v125, 1065369472
  v_mov_b32 v126, 1065369472
  v_mov_b32 v127, 1065369472
  s_waitcnt lgkmcnt(0)
  v_cndmask_b32 v128, 0, v104, s[34:35]
  v_cndmask_b32 v129, 0, v105, s[34:35]
  v_cndmask_b32 v130, 0, v106, s[34:35]
  v_cndmask_b32 v131, 0, v107, s[34:35]
  v_cndmask_b32 v132, 0, v108, s[34:35]
  v_cndmask_b32 v133, 0, v109, s[34:35]
  v_cndmask_b32 v134, 0, v110, s[34:35]
  v_cndmask_b32 v135, 0, v111, s[34:35]
  v_cndmask_b32 v136, 0, v112, s[34:35]
  v_cndmask_b32 v137, 0, v113, s[34:35]
  v_cndmask_b32 v138, 0, v114, s[34:35]
  v_cndmask_b32 v139, 0, v115, s[34:35]
  v_cndmask_b32 v140, 0, v116, s[34:35]
  v_cndmask_b32 v141, 0, v117, s[34:35]
  v_cndmask_b32 v142, 0, v118, s[34:35]
  v_cndmask_b32 v143, 0, v119, s[34:35]
  v_cndmask_b32 v144, 0, v120, s[34:35]
  v_cndmask_b32 v145, 0, v121, s[34:35]
  v_cndmask_b32 v146, 0, v122, s[34:35]
  v_cndmask_b32 v147, 0, v123, s[34:35]
  s_cmp_lt_u32 s3, 4
  s_cbranch_scc1 L_wrG
  s_cmp_eq_u32 s33, 0
  s_cselect_b32 s24, s52, s54
  s_cselect_b32 s25, s53, s55
  s_mov_b32 s26, 2211840
  s_mov_b32 s27, 0x20000
  v_lshrrev_b32 v60, 2, v1
  v_mul_u32_u24 v60, 3456, v60
  v_lshl_add_u32 v60, v7, 4, v60
  s_lshl_b32 s28, s32, 6
  s_mul_i32 s29, s69, 552960
  s_add_u32 s28, s28, s29
  s_mul_i32 s30, s69, 10240
  s_and_b32 s31, s71, 1
  s_cmp_lg_u32 s3, 6
  s_cbranch_scc1 L_nbG
  s_call_b64 s[20:21], L_balance
L_nbG:
  s_mov_b32 s78, 0
L_lw15:
  ds_read_b32 v61, v38 offset:8
  s_waitcnt lgkmcnt(0)
  v_readfirstlane_b32 s79, v61
  s_nop 0
  s_cmp_ge_u32 s79, 4
  s_nop 1
  s_cbranch_scc1 L_lwd15
  s_add_u32 s78, s78, 1
  s_cmp_gt_u32 s78, 0x400000
  s_cbranch_scc1 L_end
  s_sleep 2
  s_branch L_lw15
L_lwd15:
  s_mul_i32 s29, s31, 10
  s_lshr_b32 s29, s29, 1
  s_add_u32 s79, s29, 0
  s_lshl_b32 s78, s79, 10
  s_add_u32 m0, s30, s78
  s_mul_i32 s79, s79, 55296
  s_add_u32 s79, s79, s28
  s_add_u32 s29, s29, 1
  s_cmp_ge_u32 s29, 10
  s_cselect_b32 s29, 0, s29
  buffer_load_dwordx4 v60, s[24:27], s79 offen  lds
  s_add_u32 s79, s29, 0
  s_lshl_b32 s78, s79, 10
  s_add_u32 m0, s30, s78
  s_mul_i32 s79, s79, 55296
  s_add_u32 s79, s79, s28
  s_add_u32 s29, s29, 1
  s_cmp_ge_u32 s29, 10
  s_cselect_b32 s29, 0, s29
  buffer_load_dwordx4 v60, s[24:27], s79 offen  lds
  s_add_u32 s79, s29, 0
  s_lshl_b32 s78, s79, 10
  s_add_u32 m0, s30, s78
  s_mul_i32 s79, s79, 55296
  s_add_u32 s79, s79, s28
  s_add_u32 s29, s29, 1
  s_cmp_ge_u32 s29, 10
  s_cselect_b32 s29, 0, s29
  buffer_load_dwordx4 v60, s[24:27], s79 offen  lds
  s_add_u32 s79, s29, 0
  s_lshl_b32 s78, s79, 10
  s_add_u32 m0, s30, s78
  s_mul_i32 s79, s79, 55296
  s_add_u32 s79, s79, s28
  s_add_u32 s29, s29, 1
  s_cmp_ge_u32 s29, 10
  s_cselect_b32 s29, 0, s29
  buffer_load_dwordx4 v60, s[24:27], s79 offen  lds
  s_add_u32 s79, s29, 0
  s_lshl_b32 s78, s79, 10
  s_add_u32 m0, s30, s78
  s_mul_i32 s79, s79, 55296
  s_add_u32 s79, s79, s28
  s_add_u32 s29, s29, 1
  s_cmp_ge_u32 s29, 10
  s_cselect_b32 s29, 0, s29
  s_waitcnt vmcnt(3)
  buffer_load_dwordx4 v60, s[24:27], s79 offen  lds
  s_add_u32 s79, s29, 0
  s_lshl_b32 s78, s79, 10
  s_add_u32 m0, s30, s78
  s_mul_i32 s79, s79, 55296
  s_add_u32 s79, s79, s28
  s_add_u32 s29, s29, 1
  s_cmp_ge_u32 s29, 10
  s_cselect_b32 s29, 0, s29
  s_waitcnt vmcnt(3)
  buffer_load_dwordx4 v60, s[24:27], s79 offen  lds
  s_add_u32 s79, s29, 0
  s_lshl_b32 s78, s79, 10
  s_add_u32 m0, s30, s78
  s_mul_i32 s79, s79, 55296
  s_add_u32 s79, s79, s28
  s_add_u32 s29, s29, 1
  s_cmp_ge_u32 s29, 10
  s_cselect_b32 s29, 0, s29
  s_waitcnt vmcnt(3)
  buffer_load_dwordx4 v60, s[24:27], s79 offen  lds
  s_add_u32 s79, s29, 0
  s_lshl_b32 s78, s79, 10
  s_add_u32 m0, s30, s78
  s_mul_i32 s79, s79, 55296
  s_add_u32 s79, s79, s28
  s_add_u32 s29, s29, 1
  s_cmp_ge_u32 s29, 10
  s_cselect_b32 s29, 0, s29
  s_waitcnt vmcnt(3)
  buffer_load_dwordx4 v60, s[24:27], s79 offen  lds
  s_add_u32 s79, s29, 0
  s_lshl_b32 s78, s79, 10
  s_add_u32 m0, s30, s78
  s_mul_i32 s79, s79, 55296
  s_add_u32 s79, s79, s28
  s_add_u32 s29, s29, 1
  s_cmp_ge_u32 s29, 10
  s_cselect_b32 s29, 0, s29
  s_waitcnt vmcnt(3)
  buffer_load_dwordx4 v60, s[24:27], s79 offen  lds
  s_add_u32 s79, s29, 0
  s_lshl_b32 s78, s79, 10
  s_add_u32 m0, s30, s78
  s_mul_i32 s79, s79, 55296
  s_add_u32 s79, s79, s28
  s_add_u32 s29, s29, 1
  s_cmp_ge_u32 s29, 10
  s_cselect_b32 s29, 0, s29
  s_waitcnt vmcnt(3)
  buffer_load_dwordx4 v60, s[24:27], s79 offen  lds
  s_waitcnt vmcnt(0)
L_wrG:
  s_mov_b32 s78, 0
L_lw16:
  ds_read_b32 v61, v38 offset:4
  s_waitcnt lgkmcnt(0)
  v_readfirstlane_b32 s79, v61
  s_nop 0
  s_cmp_ge_u32 s79, 1
  s_nop 1
  s_cbranch_scc1 L_lwd16
  s_add_u32 s78, s78, 1
  s_cmp_gt_u32 s78, 0x400000
  s_cbranch_scc1 L_end
  s_sleep 2
  s_branch L_lw16
L_lwd16:
  s_add_u32 s40, s72, 1024
  s_add_u32 s41, s72, 2048
  s_add_u32 s42, s72, 3072
  s_add_u32 s43, s72, 4096
  s_cmp_lt_u32 s3, 4
  s_cbranch_scc1 L_gu_stats
  ds_read_b64_tr_b16 v[64:65], v8 offset:0
  ds_read_b64_tr_b16 v[66:67], v8 offset:256
  ds_read_b64_tr_b16 v[68:69], v8 offset:2048
  ds_read_b64_tr_b16 v[70:71], v8 offset:2304
  ds_read_b64_tr_b16 v[72:73], v8 offset:4096
  ds_read_b64_tr_b16 v[74:75], v8 offset:4352
  ds_read_b64_tr_b16 v[76:77], v8 offset:6144
  ds_read_b64_tr_b16 v[78:79], v8 offset:6400
  ds_read_b64_tr_b16 v[80:81], v8 offset:8192
  ds_read_b64_tr_b16 v[82:83], v8 offset:8448
  s_waitcnt lgkmcnt(0)
  ds_read_b64_tr_b16 v[84:85], v8 offset:32
  ds_read_b64_tr_b16 v[86:87], v8 offset:288
  ds_read_b64_tr_b16 v[88:89], v8 offset:2080
  ds_read_b64_tr_b16 v[90:91], v8 offset:2336
  ds_read_b64_tr_b16 v[92:93], v8 offset:4128
  ds_read_b64_tr_b16 v[94:95], v8 offset:4384
  ds_read_b64_tr_b16 v[96:97], v8 offset:6176
  ds_read_b64_tr_b16 v[98:99], v8 offset:6432
  ds_read_b64_tr_b16 v[100:101], v8 offset:8224
  ds_read_b64_tr_b16 v[102:103], v8 offset:8480
  s_waitcnt lgkmcnt(0)
  v_mfma_f32_16x16x32_bf16 v[52:55], v[128:131], v[64:67], 0
  v_mfma_f32_16x16x32_bf16 v[152:155], v[124:127], v[64:67], 0
  v_mfma_f32_16x16x32_bf16 v[56:59], v[128:131], v[84:87], 0
  v_mfma_f32_16x16x32_bf16 v[156:159], v[124:127], v[84:87], 0
  v_mfma_f32_16x16x32_bf16 v[52:55], v[132:135], v[68:71], v[52:55]
  v_mfma_f32_16x16x32_bf16 v[152:155], v[124:127], v[68:71], v[152:155]
  v_mfma_f32_16x16x32_bf16 v[56:59], v[132:135], v[88:91], v[56:59]
  v_mfma_f32_16x16x32_bf16 v[156:159], v[124:127], v[88:91], v[156:159]
  v_mfma_f32_16x16x32_bf16 v[52:55], v[136:139], v[72:75], v[52:55]
  v_mfma_f32_16x16x32_bf16 v[152:155], v[124:127], v[72:75], v[152:155]
  v_mfma_f32_16x16x32_bf16 v[56:59], v[136:139], v[92:95], v[56:59]
  v_mfma_f32_16x16x32_bf16 v[156:159], v[124:127], v[92:95], v[156:159]
  v_mfma_f32_16x16x32_bf16 v[52:55], v[140:143], v[76:79], v[52:55]
  v_mfma_f32_16x16x32_bf16 v[152:155], v[124:127], v[76:79], v[152:155]
  v_mfma_f32_16x16x32_bf16 v[56:59], v[140:143], v[96:99], v[56:59]
  v_mfma_f32_16x16x32_bf16 v[156:159], v[124:127], v[96:99], v[156:159]
  v_mfma_f32_16x16x32_bf16 v[52:55], v[144:147], v[80:83], v[52:55]
  v_mfma_f32_16x16x32_bf16 v[152:155], v[124:127], v[80:83], v[152:155]
  v_mfma_f32_16x16x32_bf16 v[56:59], v[144:147], v[100:103], v[56:59]
  v_mfma_f32_16x16x32_bf16 v[156:159], v[124:127], v[100:103], v[156:159]
  v_and_b32 v14, 1, v4
  v_cmp_eq_u32 vcc, 1, v14
  s_nop 5
  v_cndmask_b32 v14, v152, v156, vcc
  ds_write_b32 v30, v14 offset:4096
  s_mul_i32 s74, s33, 54
  s_add_u32 s74, s74, s32
  s_mul_i32 s74, s74, 128
  s_add_u32 s74, s74, 163840
  s_mov_b32 s75, 1027024659
  s_mov_b32 s76, 3222493025
  s_mov_b32 s77, 0x07060302
  s_waitcnt lgkmcnt(0)
  s_barrier
  ds_read_b128 v[32:35], v9 offset:0
  ds_read_b128 v[36:39], v9 offset:1152
  ds_read_b128 v[40:43], v9 offset:2304
  ds_read_b128 v[44:47], v9 offset:3456
  ds_read_b128 v[48:51], v9 offset:4608
  s_waitcnt lgkmcnt(4)
  v_mfma_f32_16x16x32_bf16 v[52:55], v[32:35], v[64:67], v[52:55]
  v_mfma_f32_16x16x32_bf16 v[56:59], v[32:35], v[84:87], v[56:59]
  s_waitcnt lgkmcnt(3)
  v_mfma_f32_16x16x32_bf16 v[52:55], v[36:39], v[68:71], v[52:55]
  v_mfma_f32_16x16x32_bf16 v[56:59], v[36:39], v[88:91], v[56:59]
  s_waitcnt lgkmcnt(2)
  v_mfma_f32_16x16x32_bf16 v[52:55], v[40:43], v[72:75], v[52:55]
  v_mfma_f32_16x16x32_bf16 v[56:59], v[40:43], v[92:95], v[56:59]
  s_waitcnt lgkmcnt(1)
  v_mfma_f32_16x16x32_bf16 v[52:55], v[44:47], v[76:79], v[52:55]
  v_mfma_f32_16x16x32_bf16 v[56:59], v[44:47], v[96:99], v[56:59]
  s_waitcnt lgkmcnt(0)
  v_mfma_f32_16x16x32_bf16 v[52:55], v[48:51], v[80:83], v[52:55]
  v_mfma_f32_16x16x32_bf16 v[56:59], v[48:51], v[100:103], v[56:59]
  s_nop 6
  v_add_f32 v52, v52, v53
  v_add_f32 v54, v54, v55
  v_add_f32 v56, v56, v57
  v_add_f32 v58, v58, v59
  v_add_f32 v52, v52, v54
  v_add_f32 v56, v56, v58
  s_nop 1
  v_permlane16_swap_b32 v52, v56
  v_add_f32 v52, v52, v56
  ds_write_b32 v30, v52
  s_branch L_gu_join
L_gu_stats:
  v_cndmask_b32 v84, 0, v124, s[34:35]
  v_cndmask_b32 v85, 0, v124, s[34:35]
  v_cndmask_b32 v86, 0, v124, s[34:35]
  v_cndmask_b32 v87, 0, v124, s[34:35]
  v_cndmask_b32 v64, v84, v104, s[36:37]
  v_cndmask_b32 v65, v85, v105, s[36:37]
  v_cndmask_b32 v66, v86, v106, s[36:37]
  v_cndmask_b32 v67, v87, v107, s[36:37]
  v_cndmask_b32 v68, v84, v108, s[36:37]
  v_cndmask_b32 v69, v85, v109, s[36:37]
  v_cndmask_b32 v70, v86, v110, s[36:37]
  v_cndmask_b32 v71, v87, v111, s[36:37]
  v_cndmask_b32 v72, v84, v112, s[36:37]
  v_cndmask_b32 v73, v85, v113, s[36:37]
  v_cndmask_b32 v74, v86, v114, s[36:37]
  v_cndmask_b32 v75, v87, v115, s[36:37]
  v_cndmask_b32 v76, v84, v116, s[36:37]
  v_cndmask_b32 v77, v85, v117, s[36:37]
  v_cndmask_b32 v78, v86, v118, s[36:37]
  v_cndmask_b32 v79, v87, v119, s[36:37]
  v_cndmask_b32 v80, v84, v120, s[36:37]
  v_cndmask_b32 v81, v85, v121, s[36:37]
  v_cndmask_b32 v82, v86, v122, s[36:37]
  v_cndmask_b32 v83, v87, v123, s[36:37]
  v_mfma_f32_16x16x32_bf16 v[52:55], v[128:131], v[128:131], 0
  v_mfma_f32_16x16x32_bf16 v[56:59], v[128:131], v[84:87], 0
  v_mfma_f32_16x16x32_bf16 v[52:55], v[132:135], v[132:135], v[52:55]
  v_mfma_f32_16x16x32_bf16 v[56:59], v[132:135], v[84:87], v[56:59]
  v_mfma_f32_16x16x32_bf16 v[52:55], v[136:139], v[136:139], v[52:55]
  v_mfma_f32_16x16x32_bf16 v[56:59], v[136:139], v[84:87], v[56:59]
  v_mfma_f32_16x16x32_bf16 v[52:55], v[140:143], v[140:143], v[52:55]
  v_mfma_f32_16x16x32_bf16 v[56:59], v[140:143], v[84:87], v[56:59]
  v_mfma_f32_16x16x32_bf16 v[52:55], v[144:147], v[144:147], v[52:55]
  v_mfma_f32_16x16x32_bf16 v[56:59], v[144:147], v[84:87], v[56:59]
  v_cndmask_b32 v16, 0, 2.0, s[36:37]
  s_mov_b32 s78, 0
  s_nop 9
L_poll17:
  buffer_load_dword v32, v18, s[12:15], s72 offen sc1
  s_waitcnt vmcnt(0)
  v_cmp_eq_u32 vcc, -1, v32
  s_nop 3
  s_cbranch_vccz L_pdone17
  s_add_u32 s78, s78, 1
  s_cmp_gt_u32 s78, 0x100000
  s_cbranch_scc1 L_end
  s_sleep 8
  s_branch L_poll17
L_pdone17:
  s_mov_b32 s78, 0
L_poll18:
  buffer_load_dwordx4 v[160:163], v19, s[12:15], s72 offen sc1
  buffer_load_dwordx4 v[164:167], v19, s[12:15], s40 offen sc1
  buffer_load_dwordx4 v[168:171], v19, s[12:15], s41 offen sc1
  buffer_load_dwordx4 v[172:175], v19, s[12:15], s42 offen sc1
  buffer_load_dwordx4 v[176:179], v19, s[12:15], s43 offen sc1
  s_waitcnt vmcnt(0)
  ds_write_b128 v17, v[160:163] offset:0
  ds_write_b128 v17, v[164:167] offset:1152
  ds_write_b128 v17, v[168:171] offset:2304
  ds_write_b128 v17, v[172:175] offset:3456
  ds_write_b128 v17, v[176:179] offset:4608
  v_max3_u32 v22, v160, v161, v162
  v_max3_u32 v23, v170, v171, v172
  v_max3_u32 v22, v22, v163, v164
  v_max3_u32 v23, v23, v173, v174
  v_max3_u32 v22, v22, v165, v166
  v_max3_u32 v23, v23, v175, v176
  v_max3_u32 v22, v22, v167, v168
  v_max3_u32 v23, v23, v177, v178
  v_max_u32 v22, v22, v169
  v_max_u32 v23, v23, v179
  v_max_u32 v22, v22, v23
  v_cmp_eq_u32 vcc, -1, v22
  s_nop 3
  s_cbranch_vccz L_pdone18
  s_add_u32 s78, s78, 1
  s_cmp_gt_u32 s78, 0x100000
  s_cbranch_scc1 L_end
  s_sleep 1
  s_branch L_poll18
L_pdone18:
  s_waitcnt lgkmcnt(0)
  s_barrier
  ds_read_b128 v[32:35], v9 offset:0
  ds_read_b128 v[36:39], v9 offset:1152
  ds_read_b128 v[40:43], v9 offset:2304
  ds_read_b128 v[44:47], v9 offset:3456
  ds_read_b128 v[48:51], v9 offset:4608
  s_waitcnt lgkmcnt(4)
  v_mfma_f32_16x16x32_bf16 v[52:55], v[32:35], v[32:35], v[52:55]
  v_mfma_f32_16x16x32_bf16 v[56:59], v[32:35], v[64:67], v[56:59]
  s_waitcnt lgkmcnt(3)
  v_mfma_f32_16x16x32_bf16 v[52:55], v[36:39], v[36:39], v[52:55]
  v_mfma_f32_16x16x32_bf16 v[56:59], v[36:39], v[68:71], v[56:59]
  s_waitcnt lgkmcnt(2)
  v_mfma_f32_16x16x32_bf16 v[52:55], v[40:43], v[40:43], v[52:55]
  v_mfma_f32_16x16x32_bf16 v[56:59], v[40:43], v[72:75], v[56:59]
  s_waitcnt lgkmcnt(1)
  v_mfma_f32_16x16x32_bf16 v[52:55], v[44:47], v[44:47], v[52:55]
  v_mfma_f32_16x16x32_bf16 v[56:59], v[44:47], v[76:79], v[56:59]
  s_waitcnt lgkmcnt(0)
  v_mfma_f32_16x16x32_bf16 v[52:55], v[48:51], v[48:51], v[52:55]
  v_mfma_f32_16x16x32_bf16 v[56:59], v[48:51], v[80:83], v[56:59]
  s_nop 6
  v_add_f32 v52, v52, v53
  v_add_f32 v54, v54, v55
  v_add_f32 v56, v56, v57
  v_add_f32 v58, v58, v59
  v_add_f32 v52, v52, v54
  v_add_f32 v53, v56, v58
  v_fmac_f32 v52, v16, v53
  s_nop 1
  v_add_f32_dpp v52, v52, v52 quad_perm:[1,0,3,2] row_mask:0xf bank_mask:0xf
  s_nop 1
  v_add_f32_dpp v52, v52, v52 quad_perm:[2,3,0,1] row_mask:0xf bank_mask:0xf
  s_nop 1
  v_add_f32_dpp v52, v52, v52 row_half_mirror row_mask:0xf bank_mask:0xf
  ds_write_b64 v29, v[52:53]
  s_nop 0
L_gu_join:
  s_waitcnt lgkmcnt(0)
  s_barrier
  s_cmp_lg_u32 s3, 4
  s_cbranch_scc1 L_fin
  ds_read_b128 v[32:35], v31 offset:0
  ds_read_b128 v[36:39], v31 offset:16
  ds_read_b128 v[40:43], v31 offset:32
  ds_read_b128 v[44:47], v31 offset:48
  ds_read_b128 v[20:23], v11
  ds_read_b128 v[24:27], v11 offset:4096
  s_waitcnt lgkmcnt(2)
  v_add_f32 v32, v32, v34
  v_add_f32 v33, v33, v35
  v_add_f32 v36, v36, v38
  v_add_f32 v37, v37, v39
  v_add_f32 v40, v40, v42
  v_add_f32 v41, v41, v43
  v_add_f32 v44, v44, v46
  v_add_f32 v45, v45, v47
  v_add_f32 v32, v32, v36
  v_add_f32 v33, v33, v37
  v_add_f32 v40, v40, v44
  v_add_f32 v41, v41, v45
  v_add_f32 v32, v32, v40
  v_add_f32 v33, v33, v41
  v_mul_f32 v33, 986500301, v33
  v_mul_f32 v32, 986500301, v32
  s_waitcnt lgkmcnt(0)
  v_fma_f32 v32, -v33, v33, v32
  v_add_f32 v20, v20, v21
  v_max_f32 v32, 0, v32
  v_add_f32 v22, v22, v23
  v_cvt_pk_bf16_f32 v34, v33, v32
  v_add_f32 v24, v24, v25
  v_and_b32 v32, 0xffff0000, v34
  v_add_f32 v26, v26, v27
  v_add_f32 v32, 925353388, v32
  v_lshlrev_b32 v33, 16, v34
  v_cvt_pk_bf16_f32 v32, v32, v32
  v_add_f32 v20, v20, v22
  v_and_b32 v32, 0xffff0000, v32
  v_add_f32 v24, v24, v26
  v_sqrt_f32 v32, v32
  v_fma_f32 v20, -v33, v24, v20
  v_cvt_pk_bf16_f32 v32, v32, v32
  v_and_b32 v32, 0xffff0000, v32
  v_rcp_f32 v32, v32
  s_cmp_lg_u32 s33, 0
  v_mul_f32 v22, v20, v32
  s_nop 0
  s_cbranch_scc1 L_gu_up
  v_cvt_pk_bf16_f32 v20, v22, v22
  v_and_b32 v20, 0xffff0000, v20
  v_mul_f32 v22, v20, v20
  v_mul_f32 v22, v22, v20
  v_fma_f32 v22, s75, v22, v20
  v_mul_f32 v22, s76, v22
  v_exp_f32 v22, v22
  s_nop 0
  v_add_f32 v22, 1.0, v22
  v_rcp_f32 v22, v22
  s_nop 0
  v_mul_f32 v22, v22, v20
  s_nop 1
L_gu_up:
  v_cvt_pk_bf16_f32 v22, v22, v22
  s_nop 1
  v_mov_b32_dpp v23, v22 quad_perm:[1,1,3,3] row_mask:0xf bank_mask:0xf
  v_perm_b32 v20, v23, v22, s77
  v_min_u32 v20, -2, v20
  s_nop 1
  v_mov_b32_dpp v21, v20 row_shl:2 row_mask:0xf bank_mask:0xf
  v_mov_b32_dpp v22, v20 row_shl:4 row_mask:0xf bank_mask:0xf
  v_mov_b32_dpp v23, v20 row_shl:6 row_mask:0xf bank_mask:0xf
  s_mov_b32 exec_lo, 0x01010101
  s_mov_b32 exec_hi, 0x01010101
  buffer_store_dwordx4 v[20:23], v28, s[12:15], s74 offen sc1
  s_mov_b64 exec, -1
  s_branch L_fin
L_role_dn:
  s_mul_i32 s70, s3, 7168
  v_add_u32 v8, s70, v8
  v_bfe_u32 v9, v1, 2, 1
  v_lshlrev_b32 v9, 6, v9
  v_lshl_add_u32 v9, v4, 4, v9
  s_lshl_b32 s70, s3, 10
  s_add_u32 s70, s70, 84480
  v_add_u32 v9, s70, v9
  v_add_u32 v17, s70, v3
  s_cmp_eq_u32 s3, 7
  s_cselect_b32 s76, 40, 56
  v_mov_b32 v16, 0x7ff00000
  v_cmp_gt_u32 vcc, s76, v1
  v_lshrrev_b32 v10, 3, v1
  v_mul_u32_u24 v10, 128, v10
  v_and_b32 v11, 7, v1
  v_lshl_add_u32 v10, v11, 4, v10
  v_cndmask_b32 v10, v16, v10, vcc
  s_mul_i32 s72, s3, 896
  s_add_u32 s72, s72, 163840
  s_add_u32 s77, s72, 6912
  v_and_b32 v11, 31, v1
  v_lshlrev_b32 v11, 5, v11
  s_lshl_b32 s70, s3, 2
  s_add_u32 s70, s70, 76288
  v_add_u32 v11, s70, v11
  s_sub_u32 s73, s71, 188
  v_and_b32 v12, 1, v4
  v_mul_u32_u24 v12, 640, v12
  v_add_u32 v12, v12, v5
  s_lshl_b32 s74, s73, 4
  v_add_u32 v12, s74, v12
  v_lshlrev_b32 v13, 1, v12
  s_lshr_b32 s74, s73, 1
  s_mul_i32 s74, s74, 1024
  s_and_b32 s75, s73, 1
  s_lshl_b32 s75, s75, 5
  s_add_u32 s74, s74, s75
  s_add_u32 s74, s74, 131072
  v_and_b32 v12, 1, v4
  v_lshlrev_b32 v12, 6, v12
  v_and_b32 v19, 14, v5
  v_lshl_add_u32 v12, v19, 1, v12
  v_mov_b32 v62, 196608
  v_and_b32 v15, 1, v1
  v_lshlrev_b32 v15, 4, v15
  v_sub_u32 v15, 16, v15
  s_cmp_lg_u32 s3, 0
  s_cbranch_scc1 L_dn_noh
  s_mov_b32 s78, 0
L_lw19:
  ds_read_b32 v61, v38 offset:4
  s_waitcnt lgkmcnt(0)
  v_readfirstlane_b32 s79, v61
  s_nop 0
  s_cmp_ge_u32 s79, 1
  s_nop 1
  s_cbranch_scc1 L_lwd19
  s_add_u32 s78, s78, 1
  s_cmp_gt_u32 s78, 0x400000
  s_cbranch_scc1 L_end
  s_sleep 2
  s_branch L_lw19
L_lwd19:
  v_add_u32 v18, 81408, v13
  ds_read_u16 v18, v18
  buffer_load_dword v63, v62, s[12:15], 0 offen sc1
  s_add_u32 s40, s74, 128
  s_add_u32 s41, s74, 256
  s_add_u32 s42, s74, 384
  s_add_u32 s43, s74, 512
  s_add_u32 s44, s74, 640
  s_add_u32 s45, s74, 768
  s_add_u32 s46, s74, 896
  s_mov_b32 s78, 0
L_poll20:
  buffer_load_dword v32, v12, s[12:15], s74 offen sc1
  buffer_load_dword v33, v12, s[12:15], s40 offen sc1
  buffer_load_dword v34, v12, s[12:15], s41 offen sc1
  buffer_load_dword v35, v12, s[12:15], s42 offen sc1
  buffer_load_dword v36, v12, s[12:15], s43 offen sc1
  buffer_load_dword v37, v12, s[12:15], s44 offen sc1
  buffer_load_dword v38, v12, s[12:15], s45 offen sc1
  buffer_load_dword v39, v12, s[12:15], s46 offen sc1
  s_waitcnt vmcnt(0)
  v_max3_u32 v22, v32, v33, v34
  v_max3_u32 v23, v36, v37, v38
  v_max_u32 v22, v22, v35
  v_max_u32 v23, v23, v39
  v_max_u32 v22, v22, v23
  v_cmp_eq_u32 vcc, -1, v22
  s_nop 3
  s_cbranch_vccz L_pdone20
  s_add_u32 s78, s78, 1
  s_cmp_gt_u32 s78, 0x100000
  s_cbranch_scc1 L_end
  s_sleep 1
  s_branch L_poll20
L_pdone20:
  v_lshlrev_b32 v32, v15, v32
  v_and_b32 v32, 0xffff0000, v32
  v_lshlrev_b32 v33, v15, v33
  v_and_b32 v33, 0xffff0000, v33
  v_lshlrev_b32 v34, v15, v34
  v_and_b32 v34, 0xffff0000, v34
  v_lshlrev_b32 v35, v15, v35
  v_and_b32 v35, 0xffff0000, v35
  v_lshlrev_b32 v36, v15, v36
  v_and_b32 v36, 0xffff0000, v36
  v_lshlrev_b32 v37, v15, v37
  v_and_b32 v37, 0xffff0000, v37
  v_lshlrev_b32 v38, v15, v38
  v_and_b32 v38, 0xffff0000, v38
  v_lshlrev_b32 v39, v15, v39
  v_and_b32 v39, 0xffff0000, v39
  v_add_f32 v32, v32, v33
  v_add_f32 v34, v34, v35
  v_add_f32 v36, v36, v37
  v_add_f32 v38, v38, v39
  v_add_f32 v32, v32, v34
  v_add_f32 v36, v36, v38
  v_add_f32 v32, v32, v36
  s_waitcnt lgkmcnt(0)
  v_lshlrev_b32 v18, 16, v18
  v_cvt_pk_bf16_f32 v14, v32, v32
  v_and_b32 v14, 0xffff0000, v14
  v_add_f32 v14, v14, v18
  v_add_u32 v63, 2654435761, v63
  v_cvt_pk_bf16_f32 v14, v14, v14
  v_and_b32 v14, 0xffff0000, v14
  s_nop 1
L_dn_noh:
  s_cmp_lt_u32 s3, 4
  s_cbranch_scc1 L_wrN
  s_mov_b32 s24, s56
  s_mov_b32 s25, s57
  s_mov_b32 s26, 2211840
  s_mov_b32 s27, 0x20000
  v_lshrrev_b32 v60, 1, v1
  v_mul_u32_u24 v60, 1280, v60
  v_and_b32 v61, 1, v1
  v_lshl_add_u32 v60, v61, 4, v60
  s_lshl_b32 s28, s73, 5
  s_mul_i32 s29, s69, 573440
  s_add_u32 s28, s28, s29
  s_mul_i32 s30, s69, 14336
  s_and_b32 s31, s71, 3
  s_cmp_lg_u32 s3, 6
  s_cbranch_scc1 L_nbN
  s_call_b64 s[20:21], L_balance
L_nbN:
  s_mov_b32 s78, 0
L_lw21:
  ds_read_b32 v61, v38 offset:8
  s_waitcnt lgkmcnt(0)
  v_readfirstlane_b32 s79, v61
  s_nop 0
  s_cmp_ge_u32 s79, 4
  s_nop 1
  s_cbranch_scc1 L_lwd21
  s_add_u32 s78, s78, 1
  s_cmp_gt_u32 s78, 0x400000
  s_cbranch_scc1 L_end
  s_sleep 2
  s_branch L_lw21
L_lwd21:
  s_mul_i32 s29, s31, 14
  s_lshr_b32 s29, s29, 2
  s_add_u32 s79, s29, 0
  s_lshl_b32 s78, s79, 10
  s_add_u32 m0, s30, s78
  s_mul_i32 s79, s79, 40960
  s_add_u32 s79, s79, s28
  s_add_u32 s29, s29, 1
  s_cmp_ge_u32 s29, 14
  s_cselect_b32 s29, 0, s29
  buffer_load_dwordx4 v60, s[24:27], s79 offen  lds
  s_add_u32 s79, s29, 0
  s_lshl_b32 s78, s79, 10
  s_add_u32 m0, s30, s78
  s_mul_i32 s79, s79, 40960
  s_add_u32 s79, s79, s28
  s_add_u32 s29, s29, 1
  s_cmp_ge_u32 s29, 14
  s_cselect_b32 s29, 0, s29
  buffer_load_dwordx4 v60, s[24:27], s79 offen  lds
  s_add_u32 s79, s29, 0
  s_lshl_b32 s78, s79, 10
  s_add_u32 m0, s30, s78
  s_mul_i32 s79, s79, 40960
  s_add_u32 s79, s79, s28
  s_add_u32 s29, s29, 1
  s_cmp_ge_u32 s29, 14
  s_cselect_b32 s29, 0, s29
  s_waitcnt vmcnt(1)
  buffer_load_dwordx4 v60, s[24:27], s79 offen  lds
  s_add_u32 s79, s29, 0
  s_lshl_b32 s78, s79, 10
  s_add_u32 m0, s30, s78
  s_mul_i32 s79, s79, 40960
  s_add_u32 s79, s79, s28
  s_add_u32 s29, s29, 1
  s_cmp_ge_u32 s29, 14
  s_cselect_b32 s29, 0, s29
  s_waitcnt vmcnt(1)
  buffer_load_dwordx4 v60, s[24:27], s79 offen  lds
  s_add_u32 s79, s29, 0
  s_lshl_b32 s78, s79, 10
  s_add_u32 m0, s30, s78
  s_mul_i32 s79, s79, 40960
  s_add_u32 s79, s79, s28
  s_add_u32 s29, s29, 1
  s_cmp_ge_u32 s29, 14
  s_cselect_b32 s29, 0, s29
  s_waitcnt vmcnt(1)
  buffer_load_dwordx4 v60, s[24:27], s79 offen  lds
  s_add_u32 s79, s29, 0
  s_lshl_b32 s78, s79, 10
  s_add_u32 m0, s30, s78
  s_mul_i32 s79, s79, 40960
  s_add_u32 s79, s79, s28
  s_add_u32 s29, s29, 1
  s_cmp_ge_u32 s29, 14
  s_cselect_b32 s29, 0, s29
  s_waitcnt vmcnt(1)
  buffer_load_dwordx4 v60, s[24:27], s79 offen  lds
  s_add_u32 s79, s29, 0
  s_lshl_b32 s78, s79, 10
  s_add_u32 m0, s30, s78
  s_mul_i32 s79, s79, 40960
  s_add_u32 s79, s79, s28
  s_add_u32 s29, s29, 1
  s_cmp_ge_u32 s29, 14
  s_cselect_b32 s29, 0, s29
  s_waitcnt vmcnt(1)
  buffer_load_dwordx4 v60, s[24:27], s79 offen  lds
  s_add_u32 s79, s29, 0
  s_lshl_b32 s78, s79, 10
  s_add_u32 m0, s30, s78
  s_mul_i32 s79, s79, 40960
  s_add_u32 s79, s79, s28
  s_add_u32 s29, s29, 1
  s_cmp_ge_u32 s29, 14
  s_cselect_b32 s29, 0, s29
  s_waitcnt vmcnt(1)
  buffer_load_dwordx4 v60, s[24:27], s79 offen  lds
  s_add_u32 s79, s29, 0
  s_lshl_b32 s78, s79, 10
  s_add_u32 m0, s30, s78
  s_mul_i32 s79, s79, 40960
  s_add_u32 s79, s79, s28
  s_add_u32 s29, s29, 1
  s_cmp_ge_u32 s29, 14
  s_cselect_b32 s29, 0, s29
  s_waitcnt vmcnt(1)
  buffer_load_dwordx4 v60, s[24:27], s79 offen  lds
  s_add_u32 s79, s29, 0
  s_lshl_b32 s78, s79, 10
  s_add_u32 m0, s30, s78
  s_mul_i32 s79, s79, 40960
  s_add_u32 s79, s79, s28
  s_add_u32 s29, s29, 1
  s_cmp_ge_u32 s29, 14
  s_cselect_b32 s29, 0, s29
  s_waitcnt vmcnt(1)
  buffer_load_dwordx4 v60, s[24:27], s79 offen  lds
  s_add_u32 s79, s29, 0
  s_lshl_b32 s78, s79, 10
  s_add_u32 m0, s30, s78
  s_mul_i32 s79, s79, 40960
  s_add_u32 s79, s79, s28
  s_add_u32 s29, s29, 1
  s_cmp_ge_u32 s29, 14
  s_cselect_b32 s29, 0, s29
  s_waitcnt vmcnt(1)
  buffer_load_dwordx4 v60, s[24:27], s79 offen  lds
  s_add_u32 s79, s29, 0
  s_lshl_b32 s78, s79, 10
  s_add_u32 m0, s30, s78
  s_mul_i32 s79, s79, 40960
  s_add_u32 s79, s79, s28
  s_add_u32 s29, s29, 1
  s_cmp_ge_u32 s29, 14
  s_cselect_b32 s29, 0, s29
  s_waitcnt vmcnt(1)
  buffer_load_dwordx4 v60, s[24:27], s79 offen  lds
  s_add_u32 s79, s29, 0
  s_lshl_b32 s78, s79, 10
  s_add_u32 m0, s30, s78
  s_mul_i32 s79, s79, 40960
  s_add_u32 s79, s79, s28
  s_add_u32 s29, s29, 1
  s_cmp_ge_u32 s29, 14
  s_cselect_b32 s29, 0, s29
  s_waitcnt vmcnt(1)
  buffer_load_dwordx4 v60, s[24:27], s79 offen  lds
  s_add_u32 s79, s29, 0
  s_lshl_b32 s78, s79, 10
  s_add_u32 m0, s30, s78
  s_mul_i32 s79, s79, 40960
  s_add_u32 s79, s79, s28
  s_add_u32 s29, s29, 1
  s_cmp_ge_u32 s29, 14
  s_cselect_b32 s29, 0, s29
  s_waitcnt vmcnt(1)
  buffer_load_dwordx4 v60, s[24:27], s79 offen  lds
  s_waitcnt vmcnt(0)
L_wrN:
  s_barrier
  s_mov_b32 s32, s58
  s_mov_b32 s33, s59
  s_mov_b32 s34, 2560
  s_mov_b32 s35, 0x20000
  s_sleep 44
  s_mov_b32 s78, 0
  buffer_load_dwordx4 v[104:107], v10, s[12:15], s72 offen sc1
  buffer_load_dwordx4 v[108:111], v10, s[12:15], s77 offen sc1
  ds_read_b64_tr_b16 v[64:65], v8 offset:0
  ds_read_b64_tr_b16 v[66:67], v8 offset:128
  ds_read_b64_tr_b16 v[68:69], v8 offset:1024
  ds_read_b64_tr_b16 v[70:71], v8 offset:1152
  ds_read_b64_tr_b16 v[72:73], v8 offset:2048
  ds_read_b64_tr_b16 v[74:75], v8 offset:2176
  ds_read_b64_tr_b16 v[76:77], v8 offset:3072
  ds_read_b64_tr_b16 v[78:79], v8 offset:3200
  ds_read_b64_tr_b16 v[80:81], v8 offset:4096
  ds_read_b64_tr_b16 v[82:83], v8 offset:4224
  ds_read_b64_tr_b16 v[84:85], v8 offset:5120
  ds_read_b64_tr_b16 v[86:87], v8 offset:5248
  ds_read_b64_tr_b16 v[88:89], v8 offset:6144
  ds_read_b64_tr_b16 v[90:91], v8 offset:6272
  s_waitcnt lgkmcnt(0)
  s_branch L_pw22
L_poll22:
  buffer_load_dwordx4 v[104:107], v10, s[12:15], s72 offen sc1
  buffer_load_dwordx4 v[108:111], v10, s[12:15], s77 offen sc1
L_pw22:
  s_waitcnt vmcnt(0)
  v_and_b32 v112, 0xffff, v104
  v_and_b32 v113, 0xffff0000, v104
  v_and_b32 v114, 0xffff, v105
  v_and_b32 v115, 0xffff0000, v105
  v_and_b32 v116, 0xffff, v106
  v_and_b32 v117, 0xffff0000, v106
  v_and_b32 v118, 0xffff, v107
  v_and_b32 v119, 0xffff0000, v107
  v_dot2_f32_bf16 v112, v112, v108, 0
  v_dot2_f32_bf16 v113, v113, v108, 0
  v_dot2_f32_bf16 v114, v114, v109, 0
  v_dot2_f32_bf16 v115, v115, v109, 0
  v_dot2_f32_bf16 v116, v116, v110, 0
  v_dot2_f32_bf16 v117, v117, v110, 0
  v_dot2_f32_bf16 v118, v118, v111, 0
  v_dot2_f32_bf16 v119, v119, v111, 0
  v_cvt_pk_bf16_f32 v120, v112, v113
  v_cvt_pk_bf16_f32 v121, v114, v115
  v_cvt_pk_bf16_f32 v122, v116, v117
  v_cvt_pk_bf16_f32 v123, v118, v119
  ds_write_b128 v17, v[120:123]
  ds_read_b128 v[32:35], v9 offset:0
  ds_read_b128 v[36:39], v9 offset:128
  ds_read_b128 v[40:43], v9 offset:256
  ds_read_b128 v[44:47], v9 offset:384
  ds_read_b128 v[48:51], v9 offset:512
  ds_read_b128 v[52:55], v9 offset:640
  ds_read_b128 v[56:59], v9 offset:768
  v_max3_u32 v22, v104, v105, v106
  v_max3_u32 v23, v108, v109, v110
  v_max_u32 v22, v22, v107
  v_max_u32 v23, v23, v111
  v_max_u32 v22, v22, v23
  v_cmp_eq_u32 vcc, -1, v22
  s_nop 3
  s_cbranch_vccz L_pdone22
  s_add_u32 s78, s78, 1
  s_cmp_gt_u32 s78, 0x100000
  s_cbranch_scc1 L_end
  s_sleep 1
  s_branch L_poll22
L_pdone22:
  s_waitcnt lgkmcnt(6)
  v_mfma_f32_16x16x32_bf16 v[96:99], v[32:35], v[64:67], 0
  s_waitcnt lgkmcnt(5)
  v_mfma_f32_16x16x32_bf16 v[100:103], v[36:39], v[68:71], 0
  s_waitcnt lgkmcnt(4)
  v_mfma_f32_16x16x32_bf16 v[96:99], v[40:43], v[72:75], v[96:99]
  s_waitcnt lgkmcnt(3)
  v_mfma_f32_16x16x32_bf16 v[100:103], v[44:47], v[76:79], v[100:103]
  s_waitcnt lgkmcnt(2)
  v_mfma_f32_16x16x32_bf16 v[96:99], v[48:51], v[80:83], v[96:99]
  s_waitcnt lgkmcnt(1)
  v_mfma_f32_16x16x32_bf16 v[100:103], v[52:55], v[84:87], v[100:103]
  s_waitcnt lgkmcnt(0)
  v_mfma_f32_16x16x32_bf16 v[96:99], v[56:59], v[88:91], v[96:99]
  s_nop 7
  v_add_f32 v96, v96, v100
  ds_write_b32 v11, v96
  s_waitcnt lgkmcnt(0)
  s_barrier
  s_cmp_lg_u32 s3, 0
  s_cbranch_scc1 L_fin
  ds_read_b128 v[20:23], v11
  ds_read_b128 v[24:27], v11 offset:16
  s_waitcnt lgkmcnt(0)
  v_add_f32 v20, v20, v21
  v_add_f32 v22, v22, v23
  v_add_f32 v24, v24, v25
  v_add_f32 v26, v26, v27
  v_add_f32 v20, v20, v22
  v_add_f32 v24, v24, v26
  v_add_f32 v20, v20, v24
  v_cvt_pk_bf16_f32 v20, v20, v20
  v_and_b32 v20, 0xffff0000, v20
  v_add_f32 v20, v20, v14
  v_cvt_pk_bf16_f32 v20, v20, v20
  s_mov_b32 exec_hi, 0
  buffer_store_short v20, v13, s[32:35], 0 offen
  s_cmp_lg_u32 s73, 0
  s_cbranch_scc1 L_noep
  s_mov_b64 exec, 1
  buffer_store_dword v63, v62, s[12:15], 0 offen sc1
L_noep:
  s_mov_b64 exec, -1
L_fin:
L_end:
  s_endpgm
.section .rodata,"a"
.p2align 6
.amdhsa_kernel sequential_preLN__gqa_block_cached__geglu_ffn__decode_kernel
  .amdhsa_next_free_vgpr 256
  .amdhsa_next_free_sgpr 102
  .amdhsa_accum_offset 256
  .amdhsa_group_segment_fixed_size 0
  .amdhsa_kernarg_size 96
  .amdhsa_user_sgpr_count 2
  .amdhsa_user_sgpr_kernarg_segment_ptr 1
  .amdhsa_system_sgpr_workgroup_id_x 1
  .amdhsa_float_denorm_mode_32 3
.end_amdhsa_kernel
```
